```python
import torch

def _softmax(x, axis=-1):
    return torch.softmax(x, dim=axis)
def _gelu(x):
    return torch.nn.functional.gelu(x, approximate="tanh")
def _silu(x):
    return torch.nn.functional.silu(x)
def _sigmoid(x):
    return torch.sigmoid(x)
def _layernorm(x, axis=-1, eps=1e-5):
    m = x.mean(dim=axis, keepdim=True)
    v = x.var(dim=axis, keepdim=True, unbiased=False)
    return (x - m) / torch.sqrt(v + eps)
def _scatter_add(tgt, idx, src, axis=0):
    return tgt.clone().index_add_(axis, idx, src)
def _segment_sum(src, seg, n):
    out = torch.zeros((n,) + src.shape[1:], dtype=src.dtype)
    return out.index_add_(0, seg, src)
def _pad(x, pw):
    flat = tuple(v for pair in reversed(pw) for v in pair)
    return torch.nn.functional.pad(x, flat)

kernel_name = 'standalone__gqa_softmax__sampling'

def setup_inputs():

    _w = (lambda a: (lambda t: t.to(torch.bfloat16) if t.is_floating_point() else t)(torch.as_tensor(a)))
    B, Hq, Hkv, Sq, Sk, D = 8, 32, 16, 16, 8192, 128
    return {
        "q": _w((lambda *s: torch.randn(*s, dtype=torch.bfloat16) * 0.8)(B, Hq, Sq, D)),
        "k": _w((lambda *s: torch.randn(*s, dtype=torch.bfloat16) * 0.8)(B, Hkv, Sk, D)),
        "v": _w((lambda *s: torch.randn(*s, dtype=torch.bfloat16) * 0.05)(B, Hkv, Sk, D)),
    }

def reference(q, k, v):
    B, Hq, Sq, D = q.shape
    Hkv = k.shape[1]
    rep = Hq // Hkv
    k = (lambda x, n, axis: torch.repeat_interleave(x, n, dim=axis))(k, rep, axis=1)
    v = (lambda x, n, axis: torch.repeat_interleave(x, n, dim=axis))(v, rep, axis=1)
    scale = D ** -0.5
    scores = torch.einsum("bhqd,bhkd->bhqk", q, k) * scale
    p = _softmax(scores, axis=-1)
    return torch.einsum("bhqk,bhkd->bhqd", p, v)
```

```asm
; @launch grid=(256,1,1) block=(256,1,1) lds=141312
.amdgcn_target "amdgcn-amd-amdhsa--gfx950"
.text
.globl standalone__gqa_softmax__sampling_kernel
.p2align 8
.type standalone__gqa_softmax__sampling_kernel,@function
standalone__gqa_softmax__sampling_kernel:
    s_cmp_ge_u32 s2, 256
    s_cbranch_scc1 L_end
    s_load_dwordx8 s[4:11], s[0:1], 0
    s_load_dwordx4 s[12:15], s[0:1], 32
    s_cmp_ge_u32 s2, 8
    s_cbranch_scc1 L_nopf
    s_getpc_b64 s[56:57]
L_pc0:
    v_lshlrev_b32 v3, 7, v0
    v_min_u32 v3, L_codeend-L_pc0-4, v3
    global_load_dword v253, v3, s[56:57]
L_nopf:
    v_lshrrev_b32 v3, 6, v0
    v_and_b32 v0, 63, v0
    v_readfirstlane_b32 s40, v3
    v_and_b32 v8, 15, v0
    v_lshrrev_b32 v9, 4, v0
    s_andn2_b32 s45, 1, s2
    s_brev_b32 s50, s2
    s_bfe_u32 s50, s50, 0x3001c
    s_lshr_b32 s44, s2, 4
    s_lshl_b32 s44, s44, 3
    s_or_b32 s44, s44, s50
    v_lshlrev_b32 v10, 2, v9
    v_xor_b32 v10, v10, v8
    v_lshlrev_b32 v10, 4, v10
    v_lshl_add_u32 v10, v9, 8, v10
    s_lshl_b32 s23, s45, 15
    s_lshl_b32 s47, s40, 12
    s_or_b32 s23, s23, s47
    s_lshl_b32 s51, s44, 21
    s_lshl_b32 s64, s40, 14
    v_add_u32 v80, s23, v10
    s_mov_b32 m0, s64
    v_xor_b32 v81, 16, v80
    v_xor_b32 v82, 32, v80
    v_xor_b32 v83, 48, v80
    s_mov_b32 s18, 0x200000
    s_mov_b32 s19, 0x20000
    s_movk_i32 s42, 0x4000
    s_add_u32 s65, s64, 0x1000
    s_waitcnt lgkmcnt(0)
    s_add_u32 s16, s6, s51
    s_addc_u32 s17, s7, 0
    buffer_load_dwordx4 v80, s[16:19], 0 offen offset:0 nt lds
    buffer_load_dwordx4 v81, s[16:19], 0 offen offset:1024 nt lds
    buffer_load_dwordx4 v82, s[16:19], 0 offen offset:2048 nt lds
    buffer_load_dwordx4 v83, s[16:19], 0 offen offset:3072 nt lds
    s_lshl_b32 s52, s44, 13
    s_and_b32 s53, s40, 1
    s_lshl_b32 s53, s53, 5
    s_lshl_b32 s54, s40, 11
    v_xor_b32 v11, s53, v10
    v_add_u32 v11, s54, v11
    v_xor_b32 v12, 16, v11
    s_add_u32 m0, s54, 131072
    s_add_u32 s24, s4, s52
    s_addc_u32 s25, s5, 0
    s_movk_i32 s26, 0x2000
    s_mov_b32 s27, 0x20000
    buffer_load_dwordx4 v11, s[24:27], 0 offen lds
    buffer_load_dwordx4 v12, s[24:27], 0 offen offset:1024 lds
    s_mov_b32 m0, s65
    s_nop 0
    buffer_load_dwordx4 v80, s[16:19], s42 offen offset:0 nt lds
    v_add_u32 v80, 0x10000, v80
    buffer_load_dwordx4 v81, s[16:19], s42 offen offset:1024 nt lds
    v_add_u32 v81, 0x10000, v81
    buffer_load_dwordx4 v82, s[16:19], s42 offen offset:2048 nt lds
    v_add_u32 v82, 0x10000, v82
    buffer_load_dwordx4 v83, s[16:19], s42 offen offset:3072 nt lds
    v_add_u32 v83, 0x10000, v83
    s_mov_b32 s32, s14
    s_mov_b32 s33, s15
    s_mov_b32 s34, 0x800000
    s_mov_b32 s35, 0x20000
    s_lshl_b32 s53, s44, 16
    s_lshl_b32 s54, s40, 7
    s_add_u32 s54, s53, s54
    s_add_u32 s54, s54, 20480
    v_mov_b32 v73, s54
    s_add_u32 s66, s64, 0x2000
    s_add_u32 s67, s64, 0x3000
    buffer_load_dword v72, v73, s[32:35], 0 offen sc0 sc1
    s_mov_b32 m0, s66
    s_nop 0
    buffer_load_dwordx4 v80, s[16:19], 0 offen offset:0 nt lds
    buffer_load_dwordx4 v81, s[16:19], 0 offen offset:1024 nt lds
    buffer_load_dwordx4 v82, s[16:19], 0 offen offset:2048 nt lds
    buffer_load_dwordx4 v83, s[16:19], 0 offen offset:3072 nt lds
    s_mov_b32 m0, s67
    s_nop 0
    buffer_load_dwordx4 v80, s[16:19], s42 offen offset:0 nt lds
    v_add_u32 v80, 0x10000, v80
    buffer_load_dwordx4 v81, s[16:19], s42 offen offset:1024 nt lds
    v_add_u32 v81, 0x10000, v81
    buffer_load_dwordx4 v82, s[16:19], s42 offen offset:2048 nt lds
    v_add_u32 v82, 0x10000, v82
    buffer_load_dwordx4 v83, s[16:19], s42 offen offset:3072 nt lds
    v_add_u32 v83, 0x10000, v83
    s_add_u32 s20, s8, s51
    s_addc_u32 s21, s9, 0
    s_add_u32 s36, s10, s52
    s_addc_u32 s37, s11, 0
    s_movk_i32 s38, 0x2000
    s_mov_b32 s39, 0x20000
    s_movk_i32 s41, 0x1000
    s_add_u32 s47, s47, 114688
    s_mov_b32 s43, 0x3e0293ee
    v_and_b32 v10, 3, v8
    v_lshrrev_b32 v11, 2, v8
    v_lshl_add_u32 v13, v10, 2, v11
    v_xor_b32 v12, v8, v9
    v_lshlrev_b32 v12, 4, v12
    v_lshl_add_u32 v12, v13, 8, v12
    v_add_u32 v84, s64, v12
    v_xor_b32 v85, 64, v84
    v_xor_b32 v86, 128, v84
    v_xor_b32 v87, 192, v84
    v_add_u32 v16, 131072, v12
    v_xor_b32 v17, 64, v16
    v_xor_b32 v18, 128, v16
    v_xor_b32 v19, 192, v16
    s_mov_b32 s28, s12
    s_mov_b32 s29, s13
    s_movk_i32 s30, 0x100
    s_mov_b32 s31, 0x20000
    s_and_b32 s53, s2, 7
    s_lshl_b32 s53, s53, 5
    v_and_b32 v14, 31, v0
    v_add_u32 v252, s53, v14
    s_lshr_b32 s55, s2, 3
    s_add_u32 s53, s53, s55
    v_mov_b32 v251, s53
    v_mov_b32 v254, 0
    v_mov_b32 v4, 0xff800000
    v_mov_b32 v6, 0
    s_waitcnt vmcnt(8)
    s_barrier
    ds_read_b128 v[160:163], v16 offset:0
    ds_read_b128 v[164:167], v17 offset:0
    ds_read_b128 v[168:171], v18 offset:0
    ds_read_b128 v[172:175], v19 offset:0
    ds_read_b128 v[176:179], v16 offset:4096
    ds_read_b128 v[180:183], v17 offset:4096
    ds_read_b128 v[184:187], v18 offset:4096
    ds_read_b128 v[188:191], v19 offset:4096
    v_add_u32 v72, 0x9e3779b9, v72
    v_mov_b32 v253, 0
    s_waitcnt lgkmcnt(0)
    s_call_b64 s[68:69], L_bodyK0
    v_accvgpr_write_b32 a0, v32
    v_accvgpr_write_b32 a1, v33
    v_accvgpr_write_b32 a2, v34
    v_accvgpr_write_b32 a3, v35
    v_accvgpr_write_b32 a4, v36
    v_accvgpr_write_b32 a5, v37
    v_accvgpr_write_b32 a6, v38
    v_accvgpr_write_b32 a7, v39
    v_mov_b32 v192, v7
    s_call_b64 s[68:69], L_bodyK1
    v_accvgpr_write_b32 a8, v32
    v_accvgpr_write_b32 a9, v33
    v_accvgpr_write_b32 a10, v34
    v_accvgpr_write_b32 a11, v35
    v_accvgpr_write_b32 a12, v36
    v_accvgpr_write_b32 a13, v37
    v_accvgpr_write_b32 a14, v38
    v_accvgpr_write_b32 a15, v39
    v_mov_b32 v193, v7
    s_call_b64 s[68:69], L_bodyK0
    v_accvgpr_write_b32 a16, v32
    v_accvgpr_write_b32 a17, v33
    v_accvgpr_write_b32 a18, v34
    v_accvgpr_write_b32 a19, v35
    v_accvgpr_write_b32 a20, v36
    v_accvgpr_write_b32 a21, v37
    v_accvgpr_write_b32 a22, v38
    v_accvgpr_write_b32 a23, v39
    v_mov_b32 v194, v7
    v_and_b32 v8, 15, v0
    v_lshrrev_b32 v9, 4, v0
    v_and_b32 v14, 1, v9
    v_lshlrev_b32 v10, 3, v14
    v_xor_b32 v10, v10, v8
    v_lshlrev_b32 v10, 4, v10
    v_lshl_add_u32 v10, v9, 8, v10
    v_add_u32 v1, s23, v10
    v_and_b32 v10, 3, v8
    v_lshrrev_b32 v11, 2, v8
    v_lshl_add_u32 v13, v10, 2, v11
    s_lshl_b32 s55, s40, 6
    v_lshl_add_u32 v13, v13, 8, s55
    v_lshl_add_u32 v13, v14, 5, v13
    v_lshrrev_b32 v14, 5, v0
    v_lshl_add_u32 v2, v14, 4, v13
    s_lshl_b32 s53, s40, 8
    s_add_u32 s53, s53, 139264
    v_lshl_add_u32 v248, v8, 3, s53
    v_lshl_add_u32 v248, v14, 7, v248
    s_call_b64 s[68:69], L_bodyK1
    v_accvgpr_write_b32 a24, v32
    v_accvgpr_write_b32 a25, v33
    v_accvgpr_write_b32 a26, v34
    v_accvgpr_write_b32 a27, v35
    v_accvgpr_write_b32 a28, v36
    v_accvgpr_write_b32 a29, v37
    v_accvgpr_write_b32 a30, v38
    v_accvgpr_write_b32 a31, v39
    v_mov_b32 v195, v7
    v_lshrrev_b32 v9, 4, v0
    v_and_b32 v10, 3, v0
    v_bfe_u32 v11, v0, 2, 2
    v_lshl_add_u32 v12, v11, 2, v9
    v_lshlrev_b32 v12, 8, v12
    v_and_b32 v14, 1, v9
    v_lshlrev_b32 v14, 3, v14
    v_lshl_add_u32 v14, v11, 1, v14
    v_lshrrev_b32 v15, 1, v10
    v_add_u32 v14, v14, v15
    v_lshl_add_u32 v12, v14, 4, v12
    v_and_b32 v15, 1, v10
    v_lshl_add_u32 v12, v15, 3, v12
    s_lshl_b32 s55, s40, 6
    v_xor_b32 v249, s55, v12
    v_xor_b32 v255, 32, v249
    v_add_u32 v88, s64, v249
    v_xor_b32 v89, 32, v88
    v_xor_b32 v90, 64, v88
    v_xor_b32 v91, 96, v88
    v_xor_b32 v92, 128, v88
    v_xor_b32 v93, 160, v88
    v_xor_b32 v94, 192, v88
    v_xor_b32 v95, 224, v88
    s_call_b64 s[68:69], L_bodyK0
    v_accvgpr_write_b32 a32, v32
    v_accvgpr_write_b32 a33, v33
    v_accvgpr_write_b32 a34, v34
    v_accvgpr_write_b32 a35, v35
    v_accvgpr_write_b32 a36, v36
    v_accvgpr_write_b32 a37, v37
    v_accvgpr_write_b32 a38, v38
    v_accvgpr_write_b32 a39, v39
    v_mov_b32 v196, v7
    s_lshl_b32 s53, s44, 16
    s_lshl_b32 s55, s45, 15
    s_add_u32 s53, s53, s55
    s_mul_i32 s55, s40, 5120
    s_add_u32 s53, s53, s55
    v_lshl_add_u32 v75, v0, 4, s53
    v_xor_b32 v74, 0x8000, v75
    s_xor_b32 s53, s40, 1
    s_mul_i32 s53, s53, 12288
    s_add_u32 s53, s53, 65536
    v_lshl_add_u32 v76, v0, 4, s53
    s_xor_b32 s53, s40, 2
    s_mul_i32 s53, s53, 12288
    s_add_u32 s53, s53, 69632
    v_lshl_add_u32 v77, v0, 4, s53
    s_xor_b32 s53, s40, 3
    s_mul_i32 s53, s53, 12288
    s_add_u32 s53, s53, 73728
    v_lshl_add_u32 v78, v0, 4, s53
    s_mul_i32 s53, s40, 12288
    s_add_u32 s53, s53, 65536
    v_lshl_add_u32 v79, v0, 4, s53
    s_call_b64 s[68:69], L_bodyK1
    v_accvgpr_write_b32 a40, v32
    v_accvgpr_write_b32 a41, v33
    v_accvgpr_write_b32 a42, v34
    v_accvgpr_write_b32 a43, v35
    v_accvgpr_write_b32 a44, v36
    v_accvgpr_write_b32 a45, v37
    v_accvgpr_write_b32 a46, v38
    v_accvgpr_write_b32 a47, v39
    v_mov_b32 v197, v7
    v_mov_b32 v96, 0
    v_mov_b32 v97, 0
    v_mov_b32 v98, 0
    v_mov_b32 v99, 0
    v_mov_b32 v100, 0
    v_mov_b32 v101, 0
    v_mov_b32 v102, 0
    v_mov_b32 v103, 0
    v_mov_b32 v104, 0
    v_mov_b32 v105, 0
    v_mov_b32 v106, 0
    v_mov_b32 v107, 0
    v_mov_b32 v108, 0
    v_mov_b32 v109, 0
    v_mov_b32 v110, 0
    v_mov_b32 v111, 0
    s_call_b64 s[68:69], L_bodyK0
    v_accvgpr_write_b32 a48, v32
    v_accvgpr_write_b32 a49, v33
    v_accvgpr_write_b32 a50, v34
    v_accvgpr_write_b32 a51, v35
    v_accvgpr_write_b32 a52, v36
    v_accvgpr_write_b32 a53, v37
    v_accvgpr_write_b32 a54, v38
    v_accvgpr_write_b32 a55, v39
    v_mov_b32 v198, v7
    v_mov_b32 v112, 0
    v_mov_b32 v113, 0
    v_mov_b32 v114, 0
    v_mov_b32 v115, 0
    v_mov_b32 v116, 0
    v_mov_b32 v117, 0
    v_mov_b32 v118, 0
    v_mov_b32 v119, 0
    v_mov_b32 v120, 0
    v_mov_b32 v121, 0
    v_mov_b32 v122, 0
    v_mov_b32 v123, 0
    v_mov_b32 v124, 0
    v_mov_b32 v125, 0
    v_mov_b32 v126, 0
    v_mov_b32 v127, 0
    s_call_b64 s[68:69], L_bodyK1
    v_accvgpr_write_b32 a56, v32
    v_accvgpr_write_b32 a57, v33
    v_accvgpr_write_b32 a58, v34
    v_accvgpr_write_b32 a59, v35
    v_accvgpr_write_b32 a60, v36
    v_accvgpr_write_b32 a61, v37
    v_accvgpr_write_b32 a62, v38
    v_accvgpr_write_b32 a63, v39
    v_mov_b32 v199, v7
    v_mov_b32 v128, 0
    v_mov_b32 v129, 0
    v_mov_b32 v130, 0
    v_mov_b32 v131, 0
    v_mov_b32 v132, 0
    v_mov_b32 v133, 0
    v_mov_b32 v134, 0
    v_mov_b32 v135, 0
    v_mov_b32 v136, 0
    v_mov_b32 v137, 0
    v_mov_b32 v138, 0
    v_mov_b32 v139, 0
    v_mov_b32 v140, 0
    v_mov_b32 v141, 0
    v_mov_b32 v142, 0
    v_mov_b32 v143, 0
    s_call_b64 s[68:69], L_bodyK0
    v_accvgpr_write_b32 a64, v32
    v_accvgpr_write_b32 a65, v33
    v_accvgpr_write_b32 a66, v34
    v_accvgpr_write_b32 a67, v35
    v_accvgpr_write_b32 a68, v36
    v_accvgpr_write_b32 a69, v37
    v_accvgpr_write_b32 a70, v38
    v_accvgpr_write_b32 a71, v39
    v_mov_b32 v200, v7
    v_mov_b32 v144, 0
    v_mov_b32 v145, 0
    v_mov_b32 v146, 0
    v_mov_b32 v147, 0
    v_mov_b32 v148, 0
    v_mov_b32 v149, 0
    v_mov_b32 v150, 0
    v_mov_b32 v151, 0
    v_mov_b32 v152, 0
    v_mov_b32 v153, 0
    v_mov_b32 v154, 0
    v_mov_b32 v155, 0
    v_mov_b32 v156, 0
    v_mov_b32 v157, 0
    v_mov_b32 v158, 0
    v_mov_b32 v159, 0
    s_call_b64 s[68:69], L_bodyK1
    v_accvgpr_write_b32 a72, v32
    v_accvgpr_write_b32 a73, v33
    v_accvgpr_write_b32 a74, v34
    v_accvgpr_write_b32 a75, v35
    v_accvgpr_write_b32 a76, v36
    v_accvgpr_write_b32 a77, v37
    v_accvgpr_write_b32 a78, v38
    v_accvgpr_write_b32 a79, v39
    v_mov_b32 v201, v7
    s_call_b64 s[68:69], L_bodyK0
    v_accvgpr_write_b32 a80, v32
    v_accvgpr_write_b32 a81, v33
    v_accvgpr_write_b32 a82, v34
    v_accvgpr_write_b32 a83, v35
    v_accvgpr_write_b32 a84, v36
    v_accvgpr_write_b32 a85, v37
    v_accvgpr_write_b32 a86, v38
    v_accvgpr_write_b32 a87, v39
    v_mov_b32 v202, v7
    s_call_b64 s[68:69], L_bodyK1
    v_accvgpr_write_b32 a88, v32
    v_accvgpr_write_b32 a89, v33
    v_accvgpr_write_b32 a90, v34
    v_accvgpr_write_b32 a91, v35
    v_accvgpr_write_b32 a92, v36
    v_accvgpr_write_b32 a93, v37
    v_accvgpr_write_b32 a94, v38
    v_accvgpr_write_b32 a95, v39
    v_mov_b32 v203, v7
    s_call_b64 s[68:69], L_bodyK0
    v_accvgpr_write_b32 a96, v32
    v_accvgpr_write_b32 a97, v33
    v_accvgpr_write_b32 a98, v34
    v_accvgpr_write_b32 a99, v35
    v_accvgpr_write_b32 a100, v36
    v_accvgpr_write_b32 a101, v37
    v_accvgpr_write_b32 a102, v38
    v_accvgpr_write_b32 a103, v39
    v_mov_b32 v204, v7
    s_call_b64 s[68:69], L_bodyK1
    v_accvgpr_write_b32 a104, v32
    v_accvgpr_write_b32 a105, v33
    v_accvgpr_write_b32 a106, v34
    v_accvgpr_write_b32 a107, v35
    v_accvgpr_write_b32 a108, v36
    v_accvgpr_write_b32 a109, v37
    v_accvgpr_write_b32 a110, v38
    v_accvgpr_write_b32 a111, v39
    v_mov_b32 v205, v7
    s_call_b64 s[68:69], L_bodyK0
    v_accvgpr_write_b32 a112, v32
    v_accvgpr_write_b32 a113, v33
    v_accvgpr_write_b32 a114, v34
    v_accvgpr_write_b32 a115, v35
    v_accvgpr_write_b32 a116, v36
    v_accvgpr_write_b32 a117, v37
    v_accvgpr_write_b32 a118, v38
    v_accvgpr_write_b32 a119, v39
    v_mov_b32 v206, v7
    s_call_b64 s[68:69], L_bodyK1
    v_accvgpr_write_b32 a120, v32
    v_accvgpr_write_b32 a121, v33
    v_accvgpr_write_b32 a122, v34
    v_accvgpr_write_b32 a123, v35
    v_accvgpr_write_b32 a124, v36
    v_accvgpr_write_b32 a125, v37
    v_accvgpr_write_b32 a126, v38
    v_accvgpr_write_b32 a127, v39
    v_mov_b32 v207, v7
    s_call_b64 s[68:69], L_bodyK0
    v_accvgpr_write_b32 a128, v32
    v_accvgpr_write_b32 a129, v33
    v_accvgpr_write_b32 a130, v34
    v_accvgpr_write_b32 a131, v35
    v_accvgpr_write_b32 a132, v36
    v_accvgpr_write_b32 a133, v37
    v_accvgpr_write_b32 a134, v38
    v_accvgpr_write_b32 a135, v39
    v_mov_b32 v208, v7
    s_call_b64 s[68:69], L_bodyK1
    v_accvgpr_write_b32 a136, v32
    v_accvgpr_write_b32 a137, v33
    v_accvgpr_write_b32 a138, v34
    v_accvgpr_write_b32 a139, v35
    v_accvgpr_write_b32 a140, v36
    v_accvgpr_write_b32 a141, v37
    v_accvgpr_write_b32 a142, v38
    v_accvgpr_write_b32 a143, v39
    v_mov_b32 v209, v7
    s_call_b64 s[68:69], L_bodyK0
    v_accvgpr_write_b32 a144, v32
    v_accvgpr_write_b32 a145, v33
    v_accvgpr_write_b32 a146, v34
    v_accvgpr_write_b32 a147, v35
    v_accvgpr_write_b32 a148, v36
    v_accvgpr_write_b32 a149, v37
    v_accvgpr_write_b32 a150, v38
    v_accvgpr_write_b32 a151, v39
    v_mov_b32 v210, v7
    s_call_b64 s[68:69], L_bodyK1
    v_accvgpr_write_b32 a152, v32
    v_accvgpr_write_b32 a153, v33
    v_accvgpr_write_b32 a154, v34
    v_accvgpr_write_b32 a155, v35
    v_accvgpr_write_b32 a156, v36
    v_accvgpr_write_b32 a157, v37
    v_accvgpr_write_b32 a158, v38
    v_accvgpr_write_b32 a159, v39
    v_mov_b32 v211, v7
    s_call_b64 s[68:69], L_bodyK0
    v_accvgpr_write_b32 a160, v32
    v_accvgpr_write_b32 a161, v33
    v_accvgpr_write_b32 a162, v34
    v_accvgpr_write_b32 a163, v35
    v_accvgpr_write_b32 a164, v36
    v_accvgpr_write_b32 a165, v37
    v_accvgpr_write_b32 a166, v38
    v_accvgpr_write_b32 a167, v39
    v_mov_b32 v212, v7
    s_call_b64 s[68:69], L_bodyK1
    v_accvgpr_write_b32 a168, v32
    v_accvgpr_write_b32 a169, v33
    v_accvgpr_write_b32 a170, v34
    v_accvgpr_write_b32 a171, v35
    v_accvgpr_write_b32 a172, v36
    v_accvgpr_write_b32 a173, v37
    v_accvgpr_write_b32 a174, v38
    v_accvgpr_write_b32 a175, v39
    v_mov_b32 v213, v7
    s_call_b64 s[68:69], L_bodyK0
    v_accvgpr_write_b32 a176, v32
    v_accvgpr_write_b32 a177, v33
    v_accvgpr_write_b32 a178, v34
    v_accvgpr_write_b32 a179, v35
    v_accvgpr_write_b32 a180, v36
    v_accvgpr_write_b32 a181, v37
    v_accvgpr_write_b32 a182, v38
    v_accvgpr_write_b32 a183, v39
    v_mov_b32 v214, v7
    s_call_b64 s[68:69], L_bodyK1
    v_accvgpr_write_b32 a184, v32
    v_accvgpr_write_b32 a185, v33
    v_accvgpr_write_b32 a186, v34
    v_accvgpr_write_b32 a187, v35
    v_accvgpr_write_b32 a188, v36
    v_accvgpr_write_b32 a189, v37
    v_accvgpr_write_b32 a190, v38
    v_accvgpr_write_b32 a191, v39
    v_mov_b32 v215, v7
    s_call_b64 s[68:69], L_bodyK0
    v_accvgpr_write_b32 a192, v32
    v_accvgpr_write_b32 a193, v33
    v_accvgpr_write_b32 a194, v34
    v_accvgpr_write_b32 a195, v35
    v_accvgpr_write_b32 a196, v36
    v_accvgpr_write_b32 a197, v37
    v_accvgpr_write_b32 a198, v38
    v_accvgpr_write_b32 a199, v39
    v_mov_b32 v216, v7
    s_call_b64 s[68:69], L_bodyK1
    v_accvgpr_write_b32 a200, v32
    v_accvgpr_write_b32 a201, v33
    v_accvgpr_write_b32 a202, v34
    v_accvgpr_write_b32 a203, v35
    v_accvgpr_write_b32 a204, v36
    v_accvgpr_write_b32 a205, v37
    v_accvgpr_write_b32 a206, v38
    v_accvgpr_write_b32 a207, v39
    v_mov_b32 v217, v7
    s_call_b64 s[68:69], L_bodyK0
    v_accvgpr_write_b32 a208, v32
    v_accvgpr_write_b32 a209, v33
    v_accvgpr_write_b32 a210, v34
    v_accvgpr_write_b32 a211, v35
    v_accvgpr_write_b32 a212, v36
    v_accvgpr_write_b32 a213, v37
    v_accvgpr_write_b32 a214, v38
    v_accvgpr_write_b32 a215, v39
    v_mov_b32 v218, v7
    s_call_b64 s[68:69], L_bodyK1
    v_accvgpr_write_b32 a216, v32
    v_accvgpr_write_b32 a217, v33
    v_accvgpr_write_b32 a218, v34
    v_accvgpr_write_b32 a219, v35
    v_accvgpr_write_b32 a220, v36
    v_accvgpr_write_b32 a221, v37
    v_accvgpr_write_b32 a222, v38
    v_accvgpr_write_b32 a223, v39
    v_mov_b32 v219, v7
    s_call_b64 s[68:69], L_bodyK0
    v_accvgpr_write_b32 a224, v32
    v_accvgpr_write_b32 a225, v33
    v_accvgpr_write_b32 a226, v34
    v_accvgpr_write_b32 a227, v35
    v_accvgpr_write_b32 a228, v36
    v_accvgpr_write_b32 a229, v37
    v_accvgpr_write_b32 a230, v38
    v_accvgpr_write_b32 a231, v39
    v_mov_b32 v220, v7
    s_call_b64 s[68:69], L_bodyK1
    v_accvgpr_write_b32 a232, v32
    v_accvgpr_write_b32 a233, v33
    v_accvgpr_write_b32 a234, v34
    v_accvgpr_write_b32 a235, v35
    v_accvgpr_write_b32 a236, v36
    v_accvgpr_write_b32 a237, v37
    v_accvgpr_write_b32 a238, v38
    v_accvgpr_write_b32 a239, v39
    v_mov_b32 v221, v7
    s_mov_b32 s16, s20
    s_mov_b32 s17, s21
    v_mov_b32 v80, v1
    v_xor_b32 v81, 32, v1
    v_xor_b32 v82, 64, v1
    v_xor_b32 v83, 96, v1
    s_waitcnt vmcnt(8)
    ds_read_b128 v[40:43], v84 offset:0
    ds_read_b128 v[44:47], v84 offset:4096
    ds_read_b128 v[48:51], v85 offset:0
    ds_read_b128 v[52:55], v85 offset:4096
    ds_read_b128 v[56:59], v86 offset:0
    ds_read_b128 v[60:63], v86 offset:4096
    ds_read_b128 v[64:67], v87 offset:0
    ds_read_b128 v[68:71], v87 offset:4096
    v_cmp_lt_u32 vcc, v254, v253
    v_add_u32 v254, 2, v254
    s_mov_b64 exec, 1
    buffer_store_byte v254, v251, s[28:31], 0 offen
    s_mov_b64 exec, -1
    buffer_load_ubyte v253, v252, s[28:31], 0 offen nt
    s_bcnt1_i32_b32 s50, vcc_lo
    s_cmp_ge_u32 s50, 8
    s_cselect_b64 vcc, -1, 0
    s_waitcnt lgkmcnt(0)
    s_mov_b32 m0, s64
    s_cbranch_vccnz L_w1
    s_waitcnt vmcnt(7)
L_w1:
    s_waitcnt vmcnt(8)
    buffer_load_dwordx4 v80, s[16:19], 0 offen offset:0 nt lds
    v_mfma_f32_16x16x32_bf16 v[224:227], v[40:43], v[160:163], 0
    v_mfma_f32_16x16x32_bf16 v[228:231], v[40:43], v[176:179], 0
    v_mfma_f32_16x16x32_bf16 v[232:235], v[44:47], v[160:163], 0
    v_mfma_f32_16x16x32_bf16 v[236:239], v[44:47], v[176:179], 0
    s_cbranch_vccnz L_w2
    s_waitcnt vmcnt(6)
L_w2:
    s_waitcnt vmcnt(7)
    buffer_load_dwordx4 v81, s[16:19], 0 offen offset:1024 nt lds
    v_mfma_f32_16x16x32_bf16 v[224:227], v[48:51], v[164:167], v[224:227]
    v_mfma_f32_16x16x32_bf16 v[228:231], v[48:51], v[180:183], v[228:231]
    v_mfma_f32_16x16x32_bf16 v[232:235], v[52:55], v[164:167], v[232:235]
    s_cbranch_vccnz L_w3
    s_waitcnt vmcnt(6)
L_w3:
    s_waitcnt vmcnt(7)
    buffer_load_dwordx4 v82, s[16:19], 0 offen offset:2048 nt lds
    v_mfma_f32_16x16x32_bf16 v[236:239], v[52:55], v[180:183], v[236:239]
    v_mfma_f32_16x16x32_bf16 v[224:227], v[56:59], v[168:171], v[224:227]
    v_mfma_f32_16x16x32_bf16 v[228:231], v[56:59], v[184:187], v[228:231]
    v_mfma_f32_16x16x32_bf16 v[232:235], v[60:63], v[168:171], v[232:235]
    s_cbranch_vccnz L_w4
    s_waitcnt vmcnt(6)
L_w4:
    s_waitcnt vmcnt(7)
    buffer_load_dwordx4 v83, s[16:19], 0 offen offset:3072 nt lds
    v_mfma_f32_16x16x32_bf16 v[236:239], v[60:63], v[184:187], v[236:239]
    v_mfma_f32_16x16x32_bf16 v[224:227], v[64:67], v[172:175], v[224:227]
    v_mfma_f32_16x16x32_bf16 v[228:231], v[64:67], v[188:191], v[228:231]
    v_add_u32 v3, 1, v254
    s_mov_b64 exec, 1
    buffer_store_byte v3, v251, s[28:31], 0 offen
    s_mov_b64 exec, -1
    s_mov_b32 m0, s65
    s_cbranch_vccnz L_w5
    s_waitcnt vmcnt(7)
L_w5:
    s_waitcnt vmcnt(8)
    buffer_load_dwordx4 v80, s[16:19], s42 offen offset:0 nt lds
    v_add_u32 v80, 0x10000, v80
    v_mfma_f32_16x16x32_bf16 v[232:235], v[68:71], v[172:175], v[232:235]
    v_mfma_f32_16x16x32_bf16 v[236:239], v[68:71], v[188:191], v[236:239]
    s_nop 7
    s_cbranch_vccnz L_w6
    s_waitcnt vmcnt(5)
L_w6:
    s_waitcnt vmcnt(6)
    buffer_load_dwordx4 v81, s[16:19], s42 offen offset:1024 nt lds
    v_add_u32 v81, 0x10000, v81
    v_max3_f32 v8, v224, v225, v226
    v_max3_f32 v8, v8, v227, v232
    v_max3_f32 v8, v8, v233, v234
    v_max_f32 v8, v8, v235
    v_max3_f32 v9, v228, v229, v230
    v_max3_f32 v9, v9, v231, v236
    v_max3_f32 v9, v9, v237, v238
    s_cbranch_vccnz L_w7
    s_waitcnt vmcnt(5)
L_w7:
    s_waitcnt vmcnt(6)
    buffer_load_dwordx4 v82, s[16:19], s42 offen offset:2048 nt lds
    v_add_u32 v82, 0x10000, v82
    v_max_f32 v9, v9, v239
    s_nop 1
    v_permlane32_swap_b32 v8, v9
    v_max_f32 v10, v8, v9
    v_mov_b32 v11, v10
    s_nop 1
    v_permlane16_swap_b32 v10, v11
    v_max3_f32 v5, v10, v11, v4
    s_cbranch_vccnz L_w8
    s_waitcnt vmcnt(5)
L_w8:
    s_waitcnt vmcnt(6)
    buffer_load_dwordx4 v83, s[16:19], s42 offen offset:3072 nt lds
    v_add_u32 v83, 0x10000, v83
    s_waitcnt vmcnt(8)
    ds_read_b128 v[40:43], v84 offset:8192
    ds_read_b128 v[44:47], v84 offset:12288
    ds_read_b128 v[48:51], v85 offset:8192
    ds_read_b128 v[52:55], v85 offset:12288
    ds_read_b128 v[56:59], v86 offset:8192
    ds_read_b128 v[60:63], v86 offset:12288
    ds_read_b128 v[64:67], v87 offset:8192
    ds_read_b128 v[68:71], v87 offset:12288
    v_cmp_lt_u32 vcc, v254, v253
    v_add_u32 v254, 2, v254
    s_mov_b64 exec, 1
    buffer_store_byte v254, v251, s[28:31], 0 offen
    s_mov_b64 exec, -1
    buffer_load_ubyte v253, v252, s[28:31], 0 offen nt
    s_bcnt1_i32_b32 s50, vcc_lo
    s_cmp_ge_u32 s50, 8
    s_cselect_b64 vcc, -1, 0
    s_waitcnt lgkmcnt(0)
    s_mov_b32 m0, s66
    s_cbranch_vccnz L_w9
    s_waitcnt vmcnt(7)
L_w9:
    s_waitcnt vmcnt(8)
    buffer_load_dwordx4 v80, s[16:19], 0 offen offset:0 nt lds
    v_mfma_f32_16x16x32_bf16 v[16:19], v[40:43], v[160:163], 0
    v_mfma_f32_16x16x32_bf16 v[20:23], v[40:43], v[176:179], 0
    v_mfma_f32_16x16x32_bf16 v[24:27], v[44:47], v[160:163], 0
    v_mfma_f32_16x16x32_bf16 v[28:31], v[44:47], v[176:179], 0
    s_cbranch_vccnz L_w10
    s_waitcnt vmcnt(6)
L_w10:
    s_waitcnt vmcnt(7)
    buffer_load_dwordx4 v81, s[16:19], 0 offen offset:1024 nt lds
    v_mfma_f32_16x16x32_bf16 v[16:19], v[48:51], v[164:167], v[16:19]
    v_mfma_f32_16x16x32_bf16 v[20:23], v[48:51], v[180:183], v[20:23]
    v_mfma_f32_16x16x32_bf16 v[24:27], v[52:55], v[164:167], v[24:27]
    v_mfma_f32_16x16x32_bf16 v[28:31], v[52:55], v[180:183], v[28:31]
    s_cbranch_vccnz L_w11
    s_waitcnt vmcnt(6)
L_w11:
    s_waitcnt vmcnt(7)
    buffer_load_dwordx4 v82, s[16:19], 0 offen offset:2048 nt lds
    v_mfma_f32_16x16x32_bf16 v[16:19], v[56:59], v[168:171], v[16:19]
    v_mfma_f32_16x16x32_bf16 v[20:23], v[56:59], v[184:187], v[20:23]
    v_mfma_f32_16x16x32_bf16 v[24:27], v[60:63], v[168:171], v[24:27]
    s_cbranch_vccnz L_w12
    s_waitcnt vmcnt(6)
L_w12:
    s_waitcnt vmcnt(7)
    buffer_load_dwordx4 v83, s[16:19], 0 offen offset:3072 nt lds
    v_mfma_f32_16x16x32_bf16 v[28:31], v[60:63], v[184:187], v[28:31]
    v_mfma_f32_16x16x32_bf16 v[16:19], v[64:67], v[172:175], v[16:19]
    v_mfma_f32_16x16x32_bf16 v[20:23], v[64:67], v[188:191], v[20:23]
    v_mfma_f32_16x16x32_bf16 v[24:27], v[68:71], v[172:175], v[24:27]
    v_add_u32 v3, 1, v254
    s_mov_b64 exec, 1
    buffer_store_byte v3, v251, s[28:31], 0 offen
    s_mov_b64 exec, -1
    s_mov_b32 m0, s67
    s_cbranch_vccnz L_w13
    s_waitcnt vmcnt(7)
L_w13:
    s_waitcnt vmcnt(8)
    buffer_load_dwordx4 v80, s[16:19], s42 offen offset:0 nt lds
    v_add_u32 v80, 0x10000, v80
    v_mfma_f32_16x16x32_bf16 v[28:31], v[68:71], v[188:191], v[28:31]
    s_nop 7
    s_cbranch_vccnz L_w14
    s_waitcnt vmcnt(5)
L_w14:
    s_waitcnt vmcnt(6)
    buffer_load_dwordx4 v81, s[16:19], s42 offen offset:1024 nt lds
    v_add_u32 v81, 0x10000, v81
    v_max3_f32 v8, v16, v17, v18
    v_max3_f32 v8, v8, v19, v24
    v_max3_f32 v8, v8, v25, v26
    v_max_f32 v8, v8, v27
    v_max3_f32 v9, v20, v21, v22
    v_max3_f32 v9, v9, v23, v28
    v_max3_f32 v9, v9, v29, v30
    v_max_f32 v9, v9, v31
    s_cbranch_vccnz L_w15
    s_waitcnt vmcnt(6)
L_w15:
    s_waitcnt vmcnt(6)
    buffer_load_dwordx4 v82, s[16:19], s42 offen offset:2048 nt lds
    v_add_u32 v82, 0x10000, v82
    s_nop 1
    v_permlane32_swap_b32 v8, v9
    v_max_f32 v10, v8, v9
    v_mov_b32 v11, v10
    s_nop 1
    v_permlane16_swap_b32 v10, v11
    v_max3_f32 v5, v10, v11, v5
    ds_write_b64 v248, v[4:5]
    s_cbranch_vccnz L_w16
    s_waitcnt vmcnt(7)
L_w16:
    s_waitcnt vmcnt(7)
    buffer_load_dwordx4 v83, s[16:19], s42 offen offset:3072 nt lds
    v_add_u32 v83, 0x10000, v83
    v_mov_b32 v12, v192
    v_mov_b32 v13, v192
    v_accvgpr_read_b32 v32, a0
    v_accvgpr_read_b32 v33, a1
    v_accvgpr_read_b32 v34, a2
    v_accvgpr_read_b32 v35, a3
    v_accvgpr_read_b32 v36, a4
    v_accvgpr_read_b32 v37, a5
    v_accvgpr_read_b32 v38, a6
    v_accvgpr_read_b32 v39, a7
    s_waitcnt lgkmcnt(0)
    s_barrier
    s_waitcnt vmcnt(8)
    ds_read_b64_tr_b16 v[40:41], v88 offset:0
    ds_read_b64_tr_b16 v[42:43], v88 offset:4096
    ds_read_b64_tr_b16 v[44:45], v89 offset:0
    ds_read_b64_tr_b16 v[46:47], v89 offset:4096
    ds_read_b64_tr_b16 v[48:49], v90 offset:0
    ds_read_b64_tr_b16 v[50:51], v90 offset:4096
    ds_read_b64_tr_b16 v[52:53], v91 offset:0
    ds_read_b64_tr_b16 v[54:55], v91 offset:4096
    ds_read_b64_tr_b16 v[56:57], v92 offset:0
    ds_read_b64_tr_b16 v[58:59], v92 offset:4096
    ds_read_b64_tr_b16 v[60:61], v93 offset:0
    ds_read_b64_tr_b16 v[62:63], v93 offset:4096
    ds_read_b64_tr_b16 v[64:65], v94 offset:0
    ds_read_b64_tr_b16 v[66:67], v94 offset:4096
    ds_read_b64_tr_b16 v[68:69], v95 offset:0
    ds_read_b64_tr_b16 v[70:71], v95 offset:4096
    v_cmp_lt_u32 vcc, v254, v253
    v_add_u32 v254, 2, v254
    s_mov_b64 exec, 1
    buffer_store_byte v254, v251, s[28:31], 0 offen
    s_mov_b64 exec, -1
    buffer_load_ubyte v253, v252, s[28:31], 0 offen nt
    s_bcnt1_i32_b32 s50, vcc_lo
    s_cmp_ge_u32 s50, 8
    s_cselect_b64 vcc, -1, 0
    v_permlane32_swap_b32 v12, v13
    v_mul_f32 v96, v96, v12
    v_mul_f32 v97, v97, v12
    v_mul_f32 v98, v98, v12
    v_mul_f32 v99, v99, v12
    v_mul_f32 v128, v128, v13
    v_mul_f32 v129, v129, v13
    v_mul_f32 v130, v130, v13
    v_mul_f32 v131, v131, v13
    s_waitcnt lgkmcnt(0)
    s_mov_b32 m0, s64
    s_cbranch_vccnz L_w17
    s_waitcnt vmcnt(7)
L_w17:
    s_waitcnt vmcnt(8)
    buffer_load_dwordx4 v80, s[16:19], 0 offen offset:0 nt lds
    v_mul_f32 v100, v100, v12
    v_mul_f32 v101, v101, v12
    v_mul_f32 v102, v102, v12
    v_mul_f32 v103, v103, v12
    v_mul_f32 v132, v132, v13
    v_mul_f32 v133, v133, v13
    v_mul_f32 v134, v134, v13
    v_mul_f32 v135, v135, v13
    v_mul_f32 v104, v104, v12
    v_mul_f32 v105, v105, v12
    v_mul_f32 v106, v106, v12
    v_mul_f32 v107, v107, v12
    v_mul_f32 v136, v136, v13
    v_mul_f32 v137, v137, v13
    v_mul_f32 v138, v138, v13
    v_mul_f32 v139, v139, v13
    v_mfma_f32_16x16x32_bf16 v[96:99], v[40:43], v[32:35], v[96:99]
    v_mfma_f32_16x16x32_bf16 v[128:131], v[40:43], v[36:39], v[128:131]
    v_mul_f32 v108, v108, v12
    v_mul_f32 v109, v109, v12
    v_mul_f32 v110, v110, v12
    v_mul_f32 v111, v111, v12
    v_mul_f32 v140, v140, v13
    v_mul_f32 v141, v141, v13
    v_mul_f32 v142, v142, v13
    v_mul_f32 v143, v143, v13
    v_mfma_f32_16x16x32_bf16 v[100:103], v[44:47], v[32:35], v[100:103]
    v_mfma_f32_16x16x32_bf16 v[132:135], v[44:47], v[36:39], v[132:135]
    v_mul_f32 v112, v112, v12
    v_mul_f32 v113, v113, v12
    v_mul_f32 v114, v114, v12
    v_mul_f32 v115, v115, v12
    v_mul_f32 v144, v144, v13
    v_mul_f32 v145, v145, v13
    v_mul_f32 v146, v146, v13
    v_mul_f32 v147, v147, v13
    v_mfma_f32_16x16x32_bf16 v[104:107], v[48:51], v[32:35], v[104:107]
    s_cbranch_vccnz L_w18
    s_waitcnt vmcnt(6)
L_w18:
    s_waitcnt vmcnt(7)
    buffer_load_dwordx4 v81, s[16:19], 0 offen offset:1024 nt lds
    v_mfma_f32_16x16x32_bf16 v[136:139], v[48:51], v[36:39], v[136:139]
    v_mul_f32 v116, v116, v12
    v_mul_f32 v117, v117, v12
    v_mul_f32 v118, v118, v12
    v_mul_f32 v119, v119, v12
    v_mul_f32 v148, v148, v13
    v_mul_f32 v149, v149, v13
    v_mul_f32 v150, v150, v13
    v_mul_f32 v151, v151, v13
    v_mfma_f32_16x16x32_bf16 v[108:111], v[52:55], v[32:35], v[108:111]
    v_mfma_f32_16x16x32_bf16 v[140:143], v[52:55], v[36:39], v[140:143]
    v_mul_f32 v120, v120, v12
    v_mul_f32 v121, v121, v12
    v_mul_f32 v122, v122, v12
    v_mul_f32 v123, v123, v12
    v_mul_f32 v152, v152, v13
    v_mul_f32 v153, v153, v13
    v_mul_f32 v154, v154, v13
    v_mul_f32 v155, v155, v13
    v_mfma_f32_16x16x32_bf16 v[112:115], v[56:59], v[32:35], v[112:115]
    v_mfma_f32_16x16x32_bf16 v[144:147], v[56:59], v[36:39], v[144:147]
    v_mul_f32 v124, v124, v12
    v_mul_f32 v125, v125, v12
    v_mul_f32 v126, v126, v12
    v_mul_f32 v127, v127, v12
    v_mul_f32 v156, v156, v13
    v_mul_f32 v157, v157, v13
    v_mul_f32 v158, v158, v13
    v_mul_f32 v159, v159, v13
    v_mfma_f32_16x16x32_bf16 v[116:119], v[60:63], v[32:35], v[116:119]
    v_mfma_f32_16x16x32_bf16 v[148:151], v[60:63], v[36:39], v[148:151]
    s_cbranch_vccnz L_w19
    s_waitcnt vmcnt(6)
L_w19:
    s_waitcnt vmcnt(7)
    buffer_load_dwordx4 v82, s[16:19], 0 offen offset:2048 nt lds
    v_mfma_f32_16x16x32_bf16 v[120:123], v[64:67], v[32:35], v[120:123]
    v_mfma_f32_16x16x32_bf16 v[152:155], v[64:67], v[36:39], v[152:155]
    v_mfma_f32_16x16x32_bf16 v[124:127], v[68:71], v[32:35], v[124:127]
    v_mfma_f32_16x16x32_bf16 v[156:159], v[68:71], v[36:39], v[156:159]
    v_and_b32 v176, 0xffffff7f, v248
    v_xor_b32 v177, 256, v176
    v_xor_b32 v178, 512, v176
    v_xor_b32 v179, 768, v176
    ds_read_b64 v[160:161], v176 offset:0
    ds_read_b64 v[162:163], v176 offset:128
    ds_read_b64 v[164:165], v177 offset:0
    ds_read_b64 v[166:167], v177 offset:128
    ds_read_b64 v[168:169], v178 offset:0
    ds_read_b64 v[170:171], v178 offset:128
    ds_read_b64 v[172:173], v179 offset:0
    ds_read_b64 v[174:175], v179 offset:128
    s_waitcnt lgkmcnt(0)
    v_max3_f32 v188, v161, v165, v169
    v_max_f32 v188, v188, v173
    v_max3_f32 v189, v163, v167, v171
    v_max_f32 v189, v189, v175
    v_sub_f32 v240, v160, v188
    v_sub_f32 v241, v162, v189
    v_sub_f32 v242, v164, v188
    v_sub_f32 v243, v166, v189
    v_sub_f32 v244, v168, v188
    v_sub_f32 v245, v170, v189
    v_sub_f32 v246, v172, v188
    v_sub_f32 v247, v174, v189
    v_mul_f32 v240, s43, v240
    s_cbranch_vccnz L_w20
    s_waitcnt vmcnt(6)
L_w20:
    s_waitcnt vmcnt(7)
    buffer_load_dwordx4 v83, s[16:19], 0 offen offset:3072 nt lds
    v_mul_f32 v241, s43, v241
    v_mul_f32 v242, s43, v242
    v_mul_f32 v243, s43, v243
    v_mul_f32 v244, s43, v244
    v_mul_f32 v245, s43, v245
    v_mul_f32 v246, s43, v246
    v_mul_f32 v247, s43, v247
    v_exp_f32 v240, v240
    v_exp_f32 v241, v241
    v_exp_f32 v242, v242
    v_exp_f32 v243, v243
    v_exp_f32 v244, v244
    v_exp_f32 v245, v245
    v_exp_f32 v246, v246
    v_exp_f32 v247, v247
    v_mul_f32 v14, s43, v188
    v_mul_f32 v15, s43, v189
    v_lshl_add_u32 v176, v0, 4, s47
    v_fma_f32 v224, v224, s43, -v14
    v_fma_f32 v225, v225, s43, -v14
    v_fma_f32 v226, v226, s43, -v14
    v_fma_f32 v227, v227, s43, -v14
    v_fma_f32 v232, v232, s43, -v14
    v_fma_f32 v233, v233, s43, -v14
    v_fma_f32 v234, v234, s43, -v14
    v_fma_f32 v235, v235, s43, -v14
    v_fma_f32 v228, v228, s43, -v15
    v_fma_f32 v229, v229, s43, -v15
    v_fma_f32 v230, v230, s43, -v15
    v_fma_f32 v231, v231, s43, -v15
    v_fma_f32 v236, v236, s43, -v15
    v_fma_f32 v237, v237, s43, -v15
    v_fma_f32 v238, v238, s43, -v15
    v_fma_f32 v239, v239, s43, -v15
    v_exp_f32 v224, v224
    v_exp_f32 v225, v225
    v_add_u32 v3, 1, v254
    s_mov_b64 exec, 1
    buffer_store_byte v3, v251, s[28:31], 0 offen
    s_mov_b64 exec, -1
    s_mov_b32 m0, s65
    s_cbranch_vccnz L_w21
    s_waitcnt vmcnt(7)
L_w21:
    s_waitcnt vmcnt(8)
    buffer_load_dwordx4 v80, s[16:19], s42 offen offset:0 nt lds
    v_add_u32 v80, 0x10000, v80
    v_exp_f32 v226, v226
    v_exp_f32 v227, v227
    v_exp_f32 v232, v232
    v_exp_f32 v233, v233
    v_exp_f32 v234, v234
    v_exp_f32 v235, v235
    v_exp_f32 v228, v228
    v_exp_f32 v229, v229
    v_exp_f32 v230, v230
    v_exp_f32 v231, v231
    v_exp_f32 v236, v236
    v_exp_f32 v237, v237
    v_exp_f32 v238, v238
    v_exp_f32 v239, v239
    v_add_f32 v8, v224, v225
    v_add_f32 v10, v226, v227
    v_add_f32 v8, v8, v232
    v_add_f32 v10, v10, v233
    v_add_f32 v8, v8, v234
    v_add_f32 v10, v10, v235
    v_add_f32 v8, v8, v10
    v_add_f32 v9, v228, v229
    v_add_f32 v11, v230, v231
    v_add_f32 v9, v9, v236
    v_add_f32 v11, v11, v237
    v_add_f32 v9, v9, v238
    v_add_f32 v11, v11, v239
    v_add_f32 v9, v9, v11
    v_cvt_pk_bf16_f32 v180, v224, v225
    v_cvt_pk_bf16_f32 v181, v226, v227
    v_cvt_pk_bf16_f32 v182, v232, v233
    v_cvt_pk_bf16_f32 v183, v234, v235
    s_cbranch_vccnz L_w22
    s_waitcnt vmcnt(5)
L_w22:
    s_waitcnt vmcnt(6)
    buffer_load_dwordx4 v81, s[16:19], s42 offen offset:1024 nt lds
    v_add_u32 v81, 0x10000, v81
    v_cvt_pk_bf16_f32 v184, v228, v229
    v_cvt_pk_bf16_f32 v185, v230, v231
    v_cvt_pk_bf16_f32 v186, v236, v237
    v_cvt_pk_bf16_f32 v187, v238, v239
    ds_write_b128 v176, v[180:183]
    ds_write_b128 v176, v[184:187] offset:1024
    v_fma_f32 v16, v16, s43, -v14
    v_fma_f32 v17, v17, s43, -v14
    v_fma_f32 v18, v18, s43, -v14
    v_fma_f32 v19, v19, s43, -v14
    v_fma_f32 v24, v24, s43, -v14
    v_fma_f32 v25, v25, s43, -v14
    v_fma_f32 v26, v26, s43, -v14
    v_fma_f32 v27, v27, s43, -v14
    v_fma_f32 v20, v20, s43, -v15
    v_fma_f32 v21, v21, s43, -v15
    v_fma_f32 v22, v22, s43, -v15
    v_fma_f32 v23, v23, s43, -v15
    v_fma_f32 v28, v28, s43, -v15
    v_fma_f32 v29, v29, s43, -v15
    v_fma_f32 v30, v30, s43, -v15
    v_fma_f32 v31, v31, s43, -v15
    v_exp_f32 v16, v16
    v_exp_f32 v17, v17
    v_exp_f32 v18, v18
    v_exp_f32 v19, v19
    v_exp_f32 v24, v24
    v_exp_f32 v25, v25
    v_exp_f32 v26, v26
    v_exp_f32 v27, v27
    v_exp_f32 v20, v20
    v_exp_f32 v21, v21
    v_exp_f32 v22, v22
    v_exp_f32 v23, v23
    s_cbranch_vccnz L_w23
    s_waitcnt vmcnt(5)
L_w23:
    s_waitcnt vmcnt(6)
    buffer_load_dwordx4 v82, s[16:19], s42 offen offset:2048 nt lds
    v_add_u32 v82, 0x10000, v82
    v_exp_f32 v28, v28
    v_exp_f32 v29, v29
    v_exp_f32 v30, v30
    v_exp_f32 v31, v31
    v_add_f32 v177, v16, v17
    v_add_f32 v10, v18, v19
    v_add_f32 v177, v177, v24
    v_add_f32 v10, v10, v25
    v_add_f32 v177, v177, v26
    v_add_f32 v10, v10, v27
    v_add_f32 v177, v177, v10
    v_add_f32 v178, v20, v21
    v_add_f32 v11, v22, v23
    v_add_f32 v178, v178, v28
    v_add_f32 v11, v11, v29
    v_add_f32 v178, v178, v30
    v_add_f32 v11, v11, v31
    v_add_f32 v178, v178, v11
    v_cvt_pk_bf16_f32 v160, v16, v17
    v_cvt_pk_bf16_f32 v161, v18, v19
    v_cvt_pk_bf16_f32 v162, v24, v25
    v_cvt_pk_bf16_f32 v163, v26, v27
    v_cvt_pk_bf16_f32 v164, v20, v21
    v_cvt_pk_bf16_f32 v165, v22, v23
    v_cvt_pk_bf16_f32 v166, v28, v29
    v_cvt_pk_bf16_f32 v167, v30, v31
    ds_write_b128 v176, v[160:163] offset:2048
    ds_write_b128 v176, v[164:167] offset:3072
    v_add_f32 v8, v8, v177
    v_add_f32 v9, v9, v178
    v_mov_b32 v10, v240
    v_mov_b32 v11, v241
    v_permlane32_swap_b32 v8, v9
    v_add_f32 v8, v8, v9
    v_permlane32_swap_b32 v10, v11
    v_fma_f32 v6, v6, v10, v8
    v_mov_b32 v11, v6
    s_nop 1
    v_permlane16_swap_b32 v6, v11
    v_add_f32 v6, v6, v11
    ds_write_b32 v248, v6 offset:1024
    s_cbranch_vccnz L_w24
    s_waitcnt vmcnt(5)
L_w24:
    s_waitcnt vmcnt(6)
    buffer_load_dwordx4 v83, s[16:19], s42 offen offset:3072 nt lds
    v_add_u32 v83, 0x10000, v83
    v_mov_b32 v12, v193
    v_mov_b32 v13, v193
    v_accvgpr_read_b32 v32, a8
    v_accvgpr_read_b32 v33, a9
    v_accvgpr_read_b32 v34, a10
    v_accvgpr_read_b32 v35, a11
    v_accvgpr_read_b32 v36, a12
    v_accvgpr_read_b32 v37, a13
    v_accvgpr_read_b32 v38, a14
    v_accvgpr_read_b32 v39, a15
    s_call_b64 s[68:69], L_bodyV1
    v_mov_b32 v12, v194
    v_mov_b32 v13, v194
    v_accvgpr_read_b32 v32, a16
    v_accvgpr_read_b32 v33, a17
    v_accvgpr_read_b32 v34, a18
    v_accvgpr_read_b32 v35, a19
    v_accvgpr_read_b32 v36, a20
    v_accvgpr_read_b32 v37, a21
    v_accvgpr_read_b32 v38, a22
    v_accvgpr_read_b32 v39, a23
    s_call_b64 s[68:69], L_bodyV0
    v_mov_b32 v12, v195
    v_mov_b32 v13, v195
    v_accvgpr_read_b32 v32, a24
    v_accvgpr_read_b32 v33, a25
    v_accvgpr_read_b32 v34, a26
    v_accvgpr_read_b32 v35, a27
    v_accvgpr_read_b32 v36, a28
    v_accvgpr_read_b32 v37, a29
    v_accvgpr_read_b32 v38, a30
    v_accvgpr_read_b32 v39, a31
    s_call_b64 s[68:69], L_bodyV1
    v_mov_b32 v12, v196
    v_mov_b32 v13, v196
    v_accvgpr_read_b32 v32, a32
    v_accvgpr_read_b32 v33, a33
    v_accvgpr_read_b32 v34, a34
    v_accvgpr_read_b32 v35, a35
    v_accvgpr_read_b32 v36, a36
    v_accvgpr_read_b32 v37, a37
    v_accvgpr_read_b32 v38, a38
    v_accvgpr_read_b32 v39, a39
    s_call_b64 s[68:69], L_bodyV0
    v_mov_b32 v12, v197
    v_mov_b32 v13, v197
    v_accvgpr_read_b32 v32, a40
    v_accvgpr_read_b32 v33, a41
    v_accvgpr_read_b32 v34, a42
    v_accvgpr_read_b32 v35, a43
    v_accvgpr_read_b32 v36, a44
    v_accvgpr_read_b32 v37, a45
    v_accvgpr_read_b32 v38, a46
    v_accvgpr_read_b32 v39, a47
    s_call_b64 s[68:69], L_bodyV1
    v_mov_b32 v12, v198
    v_mov_b32 v13, v198
    v_accvgpr_read_b32 v32, a48
    v_accvgpr_read_b32 v33, a49
    v_accvgpr_read_b32 v34, a50
    v_accvgpr_read_b32 v35, a51
    v_accvgpr_read_b32 v36, a52
    v_accvgpr_read_b32 v37, a53
    v_accvgpr_read_b32 v38, a54
    v_accvgpr_read_b32 v39, a55
    s_call_b64 s[68:69], L_bodyV0
    v_mov_b32 v12, v199
    v_mov_b32 v13, v199
    v_accvgpr_read_b32 v32, a56
    v_accvgpr_read_b32 v33, a57
    v_accvgpr_read_b32 v34, a58
    v_accvgpr_read_b32 v35, a59
    v_accvgpr_read_b32 v36, a60
    v_accvgpr_read_b32 v37, a61
    v_accvgpr_read_b32 v38, a62
    v_accvgpr_read_b32 v39, a63
    s_call_b64 s[68:69], L_bodyV1
    v_mov_b32 v12, v200
    v_mov_b32 v13, v200
    v_accvgpr_read_b32 v32, a64
    v_accvgpr_read_b32 v33, a65
    v_accvgpr_read_b32 v34, a66
    v_accvgpr_read_b32 v35, a67
    v_accvgpr_read_b32 v36, a68
    v_accvgpr_read_b32 v37, a69
    v_accvgpr_read_b32 v38, a70
    v_accvgpr_read_b32 v39, a71
    s_call_b64 s[68:69], L_bodyV0
    v_mov_b32 v12, v201
    v_mov_b32 v13, v201
    v_accvgpr_read_b32 v32, a72
    v_accvgpr_read_b32 v33, a73
    v_accvgpr_read_b32 v34, a74
    v_accvgpr_read_b32 v35, a75
    v_accvgpr_read_b32 v36, a76
    v_accvgpr_read_b32 v37, a77
    v_accvgpr_read_b32 v38, a78
    v_accvgpr_read_b32 v39, a79
    s_waitcnt vmcnt(8)
    ds_read_b64_tr_b16 v[40:41], v88 offset:8192
    ds_read_b64_tr_b16 v[42:43], v88 offset:12288
    ds_read_b64_tr_b16 v[44:45], v89 offset:8192
    ds_read_b64_tr_b16 v[46:47], v89 offset:12288
    ds_read_b64_tr_b16 v[48:49], v90 offset:8192
    ds_read_b64_tr_b16 v[50:51], v90 offset:12288
    ds_read_b64_tr_b16 v[52:53], v91 offset:8192
    ds_read_b64_tr_b16 v[54:55], v91 offset:12288
    ds_read_b64_tr_b16 v[56:57], v92 offset:8192
    ds_read_b64_tr_b16 v[58:59], v92 offset:12288
    ds_read_b64_tr_b16 v[60:61], v93 offset:8192
    ds_read_b64_tr_b16 v[62:63], v93 offset:12288
    ds_read_b64_tr_b16 v[64:65], v94 offset:8192
    ds_read_b64_tr_b16 v[66:67], v94 offset:12288
    ds_read_b64_tr_b16 v[68:69], v95 offset:8192
    ds_read_b64_tr_b16 v[70:71], v95 offset:12288
    v_cmp_lt_u32 vcc, v254, v253
    v_add_u32 v254, 2, v254
    s_mov_b64 exec, 1
    buffer_store_byte v254, v251, s[28:31], 0 offen
    s_mov_b64 exec, -1
    buffer_load_ubyte v253, v252, s[28:31], 0 offen nt
    s_bcnt1_i32_b32 s50, vcc_lo
    s_cmp_ge_u32 s50, 8
    s_cselect_b64 vcc, -1, 0
    v_permlane32_swap_b32 v12, v13
    v_mul_f32 v96, v96, v12
    v_mul_f32 v97, v97, v12
    v_mul_f32 v98, v98, v12
    v_mul_f32 v99, v99, v12
    v_mul_f32 v128, v128, v13
    v_mul_f32 v129, v129, v13
    v_mul_f32 v130, v130, v13
    v_mul_f32 v131, v131, v13
    s_waitcnt lgkmcnt(0)
    s_mov_b32 m0, s66
    s_cbranch_vccnz L_w25
    s_waitcnt vmcnt(7)
L_w25:
    s_waitcnt vmcnt(8)
    buffer_load_dwordx4 v80, s[16:19], 0 offen offset:0 nt lds
    v_mul_f32 v100, v100, v12
    v_mul_f32 v101, v101, v12
    v_mul_f32 v102, v102, v12
    v_mul_f32 v103, v103, v12
    v_mul_f32 v132, v132, v13
    v_mul_f32 v133, v133, v13
    v_mul_f32 v134, v134, v13
    v_mul_f32 v135, v135, v13
    v_mul_f32 v104, v104, v12
    v_mul_f32 v105, v105, v12
    v_mul_f32 v106, v106, v12
    v_mul_f32 v107, v107, v12
    v_mul_f32 v136, v136, v13
    v_mul_f32 v137, v137, v13
    v_mul_f32 v138, v138, v13
    s_cbranch_vccnz L_w26
    s_waitcnt vmcnt(6)
L_w26:
    s_waitcnt vmcnt(7)
    buffer_load_dwordx4 v81, s[16:19], 0 offen offset:1024 nt lds
    v_mul_f32 v139, v139, v13
    v_mfma_f32_16x16x32_bf16 v[96:99], v[40:43], v[32:35], v[96:99]
    v_mfma_f32_16x16x32_bf16 v[128:131], v[40:43], v[36:39], v[128:131]
    v_mul_f32 v108, v108, v12
    v_mul_f32 v109, v109, v12
    v_mul_f32 v110, v110, v12
    v_mul_f32 v111, v111, v12
    v_mul_f32 v140, v140, v13
    v_mul_f32 v141, v141, v13
    v_mul_f32 v142, v142, v13
    v_mul_f32 v143, v143, v13
    s_cbranch_vccnz L_w27
    s_waitcnt vmcnt(6)
L_w27:
    s_waitcnt vmcnt(7)
    buffer_load_dwordx4 v82, s[16:19], 0 offen offset:2048 nt lds
    v_mfma_f32_16x16x32_bf16 v[100:103], v[44:47], v[32:35], v[100:103]
    v_mfma_f32_16x16x32_bf16 v[132:135], v[44:47], v[36:39], v[132:135]
    v_mul_f32 v112, v112, v12
    v_mul_f32 v113, v113, v12
    v_mul_f32 v114, v114, v12
    v_mul_f32 v115, v115, v12
    v_mul_f32 v144, v144, v13
    v_mul_f32 v145, v145, v13
    v_mul_f32 v146, v146, v13
    v_mul_f32 v147, v147, v13
    v_mfma_f32_16x16x32_bf16 v[104:107], v[48:51], v[32:35], v[104:107]
    s_cbranch_vccnz L_w28
    s_waitcnt vmcnt(6)
L_w28:
    s_waitcnt vmcnt(7)
    buffer_load_dwordx4 v83, s[16:19], 0 offen offset:3072 nt lds
    v_mfma_f32_16x16x32_bf16 v[136:139], v[48:51], v[36:39], v[136:139]
    v_mul_f32 v116, v116, v12
    v_mul_f32 v117, v117, v12
    v_mul_f32 v118, v118, v12
    v_mul_f32 v119, v119, v12
    v_mul_f32 v148, v148, v13
    v_mul_f32 v149, v149, v13
    v_mul_f32 v150, v150, v13
    v_mul_f32 v151, v151, v13
    v_mfma_f32_16x16x32_bf16 v[108:111], v[52:55], v[32:35], v[108:111]
    v_add_u32 v3, 1, v254
    s_mov_b64 exec, 1
    buffer_store_byte v3, v251, s[28:31], 0 offen
    s_mov_b64 exec, -1
    s_mov_b32 m0, s67
    s_cbranch_vccnz L_w29
    s_waitcnt vmcnt(7)
L_w29:
    s_waitcnt vmcnt(8)
    buffer_load_dwordx4 v80, s[16:19], s42 offen offset:0 nt lds
    v_add_u32 v80, 0x10000, v80
    v_mfma_f32_16x16x32_bf16 v[140:143], v[52:55], v[36:39], v[140:143]
    v_mul_f32 v120, v120, v12
    v_mul_f32 v121, v121, v12
    v_mul_f32 v122, v122, v12
    v_mul_f32 v123, v123, v12
    v_mul_f32 v152, v152, v13
    v_mul_f32 v153, v153, v13
    v_mul_f32 v154, v154, v13
    v_mul_f32 v155, v155, v13
    v_mfma_f32_16x16x32_bf16 v[112:115], v[56:59], v[32:35], v[112:115]
    s_cbranch_vccnz L_w30
    s_waitcnt vmcnt(5)
L_w30:
    s_waitcnt vmcnt(6)
    buffer_load_dwordx4 v81, s[16:19], s42 offen offset:1024 nt lds
    v_add_u32 v81, 0x10000, v81
    v_mfma_f32_16x16x32_bf16 v[144:147], v[56:59], v[36:39], v[144:147]
    v_mul_f32 v124, v124, v12
    v_mul_f32 v125, v125, v12
    v_mul_f32 v126, v126, v12
    v_mul_f32 v127, v127, v12
    v_mul_f32 v156, v156, v13
    v_mul_f32 v157, v157, v13
    v_mul_f32 v158, v158, v13
    v_mul_f32 v159, v159, v13
    v_mfma_f32_16x16x32_bf16 v[116:119], v[60:63], v[32:35], v[116:119]
    v_mfma_f32_16x16x32_bf16 v[148:151], v[60:63], v[36:39], v[148:151]
    s_cbranch_vccnz L_w31
    s_waitcnt vmcnt(6)
L_w31:
    s_waitcnt vmcnt(6)
    buffer_load_dwordx4 v82, s[16:19], s42 offen offset:2048 nt lds
    v_add_u32 v82, 0x10000, v82
    v_mfma_f32_16x16x32_bf16 v[120:123], v[64:67], v[32:35], v[120:123]
    v_mfma_f32_16x16x32_bf16 v[152:155], v[64:67], v[36:39], v[152:155]
    v_mfma_f32_16x16x32_bf16 v[124:127], v[68:71], v[32:35], v[124:127]
    v_mfma_f32_16x16x32_bf16 v[156:159], v[68:71], v[36:39], v[156:159]
    s_cbranch_vccnz L_w32
    s_waitcnt vmcnt(7)
L_w32:
    s_waitcnt vmcnt(7)
    buffer_load_dwordx4 v83, s[16:19], s42 offen offset:3072 nt lds
    v_add_u32 v83, 0x10000, v83
    s_waitcnt lgkmcnt(0)
    s_barrier
    v_lshlrev_b32 v8, 4, v0
    v_add_u32 v8, 114688, v8
    v_and_b32 v9, 0xfffffc7f, v248
    ds_read_b32 v16, v9 offset:1024
    ds_read_b32 v17, v9 offset:1152
    ds_read_b32 v18, v9 offset:1280
    ds_read_b32 v19, v9 offset:1408
    ds_read_b32 v20, v9 offset:1536
    ds_read_b32 v21, v9 offset:1664
    ds_read_b32 v22, v9 offset:1792
    ds_read_b32 v23, v9 offset:1920
    ds_read_b128 a[0:3], v8 offset:0
    ds_read_b128 a[4:7], v8 offset:1024
    ds_read_b128 a[8:11], v8 offset:2048
    ds_read_b128 a[12:15], v8 offset:3072
    ds_read_b128 a[16:19], v8 offset:4096
    ds_read_b128 a[20:23], v8 offset:5120
    ds_read_b128 a[24:27], v8 offset:6144
    ds_read_b128 a[28:31], v8 offset:7168
    ds_read_b128 a[32:35], v8 offset:8192
    ds_read_b128 a[36:39], v8 offset:9216
    ds_read_b128 a[40:43], v8 offset:10240
    ds_read_b128 a[44:47], v8 offset:11264
    ds_read_b128 a[48:51], v8 offset:12288
    ds_read_b128 a[52:55], v8 offset:13312
    ds_read_b128 a[56:59], v8 offset:14336
    ds_read_b128 a[60:63], v8 offset:15360
    v_mov_b32 v12, v202
    v_mov_b32 v13, v202
    v_accvgpr_read_b32 v32, a80
    v_accvgpr_read_b32 v33, a81
    v_accvgpr_read_b32 v34, a82
    v_accvgpr_read_b32 v35, a83
    v_accvgpr_read_b32 v36, a84
    v_accvgpr_read_b32 v37, a85
    v_accvgpr_read_b32 v38, a86
    v_accvgpr_read_b32 v39, a87
    s_waitcnt lgkmcnt(0)
    v_add_f32 v190, v16, v18
    v_add_f32 v20, v20, v22
    v_add_f32 v190, v190, v20
    v_add_f32 v191, v17, v19
    v_add_f32 v21, v21, v23
    v_add_f32 v191, v191, v21
    s_call_b64 s[68:69], L_bodyV0
    v_mov_b32 v12, v203
    v_mov_b32 v13, v203
    v_accvgpr_read_b32 v32, a88
    v_accvgpr_read_b32 v33, a89
    v_accvgpr_read_b32 v34, a90
    v_accvgpr_read_b32 v35, a91
    v_accvgpr_read_b32 v36, a92
    v_accvgpr_read_b32 v37, a93
    v_accvgpr_read_b32 v38, a94
    v_accvgpr_read_b32 v39, a95
    v_cmp_gt_u32 s[50:51], 16, v0
    s_movk_i32 s48, 0xff
    s_mov_b32 s49, 0x0c0c0400
    s_mov_b32 s60, 0x04000c0c
    v_cndmask_b32 v224, v189, v188, s[50:51]
    v_cndmask_b32 v225, v191, v190, s[50:51]
    v_xor_b32 v226, v224, v225
    v_xor_b32 v226, v226, v72
    v_mov_b32 v227, v72
    s_mov_b32 s46, 10
    v_mov_b32 v184, v72
    v_lshrrev_b32 v185, 8, v72
    v_lshrrev_b32 v186, 16, v72
    v_lshrrev_b32 v187, 24, v72
    v_sub_u32 v85, 0, v72
    v_and_b32 v84, 0xfffffcff, v74
    s_call_b64 s[68:69], L_bodyV1
    v_mov_b32 v12, v204
    v_mov_b32 v13, v204
    v_accvgpr_read_b32 v32, a96
    v_accvgpr_read_b32 v33, a97
    v_accvgpr_read_b32 v34, a98
    v_accvgpr_read_b32 v35, a99
    v_accvgpr_read_b32 v36, a100
    v_accvgpr_read_b32 v37, a101
    v_accvgpr_read_b32 v38, a102
    v_accvgpr_read_b32 v39, a103
    s_call_b64 s[68:69], L_bodyV0
    v_mov_b32 v12, v205
    v_mov_b32 v13, v205
    v_accvgpr_read_b32 v32, a104
    v_accvgpr_read_b32 v33, a105
    v_accvgpr_read_b32 v34, a106
    v_accvgpr_read_b32 v35, a107
    v_accvgpr_read_b32 v36, a108
    v_accvgpr_read_b32 v37, a109
    v_accvgpr_read_b32 v38, a110
    v_accvgpr_read_b32 v39, a111
    s_call_b64 s[68:69], L_bodyV1
    v_mov_b32 v12, v206
    v_mov_b32 v13, v206
    v_accvgpr_read_b32 v32, a112
    v_accvgpr_read_b32 v33, a113
    v_accvgpr_read_b32 v34, a114
    v_accvgpr_read_b32 v35, a115
    v_accvgpr_read_b32 v36, a116
    v_accvgpr_read_b32 v37, a117
    v_accvgpr_read_b32 v38, a118
    v_accvgpr_read_b32 v39, a119
    s_call_b64 s[68:69], L_bodyV0
    v_mov_b32 v12, v207
    v_mov_b32 v13, v207
    v_accvgpr_read_b32 v32, a120
    v_accvgpr_read_b32 v33, a121
    v_accvgpr_read_b32 v34, a122
    v_accvgpr_read_b32 v35, a123
    v_accvgpr_read_b32 v36, a124
    v_accvgpr_read_b32 v37, a125
    v_accvgpr_read_b32 v38, a126
    v_accvgpr_read_b32 v39, a127
    s_call_b64 s[68:69], L_bodyV1
    v_mov_b32 v12, v208
    v_mov_b32 v13, v208
    v_accvgpr_read_b32 v32, a128
    v_accvgpr_read_b32 v33, a129
    v_accvgpr_read_b32 v34, a130
    v_accvgpr_read_b32 v35, a131
    v_accvgpr_read_b32 v36, a132
    v_accvgpr_read_b32 v37, a133
    v_accvgpr_read_b32 v38, a134
    v_accvgpr_read_b32 v39, a135
    s_call_b64 s[68:69], L_bodyV0
    v_mov_b32 v12, v209
    v_mov_b32 v13, v209
    v_accvgpr_read_b32 v32, a136
    v_accvgpr_read_b32 v33, a137
    v_accvgpr_read_b32 v34, a138
    v_accvgpr_read_b32 v35, a139
    v_accvgpr_read_b32 v36, a140
    v_accvgpr_read_b32 v37, a141
    v_accvgpr_read_b32 v38, a142
    v_accvgpr_read_b32 v39, a143
    s_call_b64 s[68:69], L_bodyV1
    v_mov_b32 v12, v210
    v_mov_b32 v13, v210
    v_accvgpr_read_b32 v32, a144
    v_accvgpr_read_b32 v33, a145
    v_accvgpr_read_b32 v34, a146
    v_accvgpr_read_b32 v35, a147
    v_accvgpr_read_b32 v36, a148
    v_accvgpr_read_b32 v37, a149
    v_accvgpr_read_b32 v38, a150
    v_accvgpr_read_b32 v39, a151
    s_call_b64 s[68:69], L_bodyV0
    v_mov_b32 v12, v211
    v_mov_b32 v13, v211
    v_accvgpr_read_b32 v32, a152
    v_accvgpr_read_b32 v33, a153
    v_accvgpr_read_b32 v34, a154
    v_accvgpr_read_b32 v35, a155
    v_accvgpr_read_b32 v36, a156
    v_accvgpr_read_b32 v37, a157
    v_accvgpr_read_b32 v38, a158
    v_accvgpr_read_b32 v39, a159
    s_call_b64 s[68:69], L_bodyV1
    v_mov_b32 v12, v212
    v_mov_b32 v13, v212
    v_accvgpr_read_b32 v32, a160
    v_accvgpr_read_b32 v33, a161
    v_accvgpr_read_b32 v34, a162
    v_accvgpr_read_b32 v35, a163
    v_accvgpr_read_b32 v36, a164
    v_accvgpr_read_b32 v37, a165
    v_accvgpr_read_b32 v38, a166
    v_accvgpr_read_b32 v39, a167
    s_call_b64 s[68:69], L_bodyV0
    v_mov_b32 v12, v213
    v_mov_b32 v13, v213
    v_accvgpr_read_b32 v32, a168
    v_accvgpr_read_b32 v33, a169
    v_accvgpr_read_b32 v34, a170
    v_accvgpr_read_b32 v35, a171
    v_accvgpr_read_b32 v36, a172
    v_accvgpr_read_b32 v37, a173
    v_accvgpr_read_b32 v38, a174
    v_accvgpr_read_b32 v39, a175
    s_call_b64 s[68:69], L_bodyV1
    v_mov_b32 v12, v214
    v_mov_b32 v13, v214
    v_accvgpr_read_b32 v32, a176
    v_accvgpr_read_b32 v33, a177
    v_accvgpr_read_b32 v34, a178
    v_accvgpr_read_b32 v35, a179
    v_accvgpr_read_b32 v36, a180
    v_accvgpr_read_b32 v37, a181
    v_accvgpr_read_b32 v38, a182
    v_accvgpr_read_b32 v39, a183
    s_call_b64 s[68:69], L_bodyV0
    v_mov_b32 v12, v215
    v_mov_b32 v13, v215
    v_accvgpr_read_b32 v32, a184
    v_accvgpr_read_b32 v33, a185
    v_accvgpr_read_b32 v34, a186
    v_accvgpr_read_b32 v35, a187
    v_accvgpr_read_b32 v36, a188
    v_accvgpr_read_b32 v37, a189
    v_accvgpr_read_b32 v38, a190
    v_accvgpr_read_b32 v39, a191
    s_call_b64 s[68:69], L_bodyV1
    v_mov_b32 v12, v216
    v_mov_b32 v13, v216
    v_accvgpr_read_b32 v32, a192
    v_accvgpr_read_b32 v33, a193
    v_accvgpr_read_b32 v34, a194
    v_accvgpr_read_b32 v35, a195
    v_accvgpr_read_b32 v36, a196
    v_accvgpr_read_b32 v37, a197
    v_accvgpr_read_b32 v38, a198
    v_accvgpr_read_b32 v39, a199
    s_call_b64 s[68:69], L_bodyV0
    v_mov_b32 v12, v217
    v_mov_b32 v13, v217
    v_accvgpr_read_b32 v32, a200
    v_accvgpr_read_b32 v33, a201
    v_accvgpr_read_b32 v34, a202
    v_accvgpr_read_b32 v35, a203
    v_accvgpr_read_b32 v36, a204
    v_accvgpr_read_b32 v37, a205
    v_accvgpr_read_b32 v38, a206
    v_accvgpr_read_b32 v39, a207
    s_call_b64 s[68:69], L_bodyV1
    v_mov_b32 v12, v218
    v_mov_b32 v13, v218
    v_accvgpr_read_b32 v32, a208
    v_accvgpr_read_b32 v33, a209
    v_accvgpr_read_b32 v34, a210
    v_accvgpr_read_b32 v35, a211
    v_accvgpr_read_b32 v36, a212
    v_accvgpr_read_b32 v37, a213
    v_accvgpr_read_b32 v38, a214
    v_accvgpr_read_b32 v39, a215
    s_call_b64 s[68:69], L_bodyV0
    v_mov_b32 v12, v219
    v_mov_b32 v13, v219
    v_accvgpr_read_b32 v32, a216
    v_accvgpr_read_b32 v33, a217
    v_accvgpr_read_b32 v34, a218
    v_accvgpr_read_b32 v35, a219
    v_accvgpr_read_b32 v36, a220
    v_accvgpr_read_b32 v37, a221
    v_accvgpr_read_b32 v38, a222
    v_accvgpr_read_b32 v39, a223
    s_call_b64 s[68:69], L_bodyV1
    v_mov_b32 v12, v220
    v_mov_b32 v13, v220
    v_accvgpr_read_b32 v32, a224
    v_accvgpr_read_b32 v33, a225
    v_accvgpr_read_b32 v34, a226
    v_accvgpr_read_b32 v35, a227
    v_accvgpr_read_b32 v36, a228
    v_accvgpr_read_b32 v37, a229
    v_accvgpr_read_b32 v38, a230
    v_accvgpr_read_b32 v39, a231
    s_mov_b32 s30, 0
    s_call_b64 s[68:69], L_bodyV0
    v_mov_b32 v12, v221
    v_mov_b32 v13, v221
    v_accvgpr_read_b32 v32, a232
    v_accvgpr_read_b32 v33, a233
    v_accvgpr_read_b32 v34, a234
    v_accvgpr_read_b32 v35, a235
    v_accvgpr_read_b32 v36, a236
    v_accvgpr_read_b32 v37, a237
    v_accvgpr_read_b32 v38, a238
    v_accvgpr_read_b32 v39, a239
    s_waitcnt vmcnt(8)
    ds_read_b64_tr_b16 v[40:41], v88 offset:8192
    ds_read_b64_tr_b16 v[42:43], v88 offset:12288
    ds_read_b64_tr_b16 v[44:45], v89 offset:8192
    ds_read_b64_tr_b16 v[46:47], v89 offset:12288
    ds_read_b64_tr_b16 v[48:49], v90 offset:8192
    ds_read_b64_tr_b16 v[50:51], v90 offset:12288
    ds_read_b64_tr_b16 v[52:53], v91 offset:8192
    ds_read_b64_tr_b16 v[54:55], v91 offset:12288
    ds_read_b64_tr_b16 v[56:57], v92 offset:8192
    ds_read_b64_tr_b16 v[58:59], v92 offset:12288
    ds_read_b64_tr_b16 v[60:61], v93 offset:8192
    ds_read_b64_tr_b16 v[62:63], v93 offset:12288
    ds_read_b64_tr_b16 v[64:65], v94 offset:8192
    ds_read_b64_tr_b16 v[66:67], v94 offset:12288
    ds_read_b64_tr_b16 v[68:69], v95 offset:8192
    ds_read_b64_tr_b16 v[70:71], v95 offset:12288
    v_permlane32_swap_b32 v12, v13
    v_mul_f32 v104, v104, v12
    v_mul_f32 v105, v105, v12
    v_mul_f32 v106, v106, v12
    v_mul_f32 v107, v107, v12
    v_mul_f32 v136, v136, v13
    v_mul_f32 v137, v137, v13
    v_mul_f32 v138, v138, v13
    v_mul_f32 v139, v139, v13
    s_waitcnt lgkmcnt(0)
    s_mov_b32 m0, s66
    s_nop 0
    buffer_load_dwordx4 v80, s[16:19], 0 offen offset:0 nt lds
    v_mul_f32 v108, v108, v12
    v_mul_f32 v109, v109, v12
    v_mul_f32 v110, v110, v12
    v_mul_f32 v111, v111, v12
    v_mul_f32 v140, v140, v13
    v_mul_f32 v141, v141, v13
    v_mul_f32 v142, v142, v13
    v_mul_f32 v143, v143, v13
    v_mul_f32 v112, v112, v12
    v_mul_f32 v113, v113, v12
    v_mul_f32 v114, v114, v12
    v_mul_f32 v115, v115, v12
    v_mul_f32 v144, v144, v13
    v_mul_f32 v145, v145, v13
    v_mul_f32 v146, v146, v13
    v_mul_f32 v147, v147, v13
    v_mfma_f32_16x16x32_bf16 v[104:107], v[48:51], v[32:35], v[104:107]
    buffer_load_dwordx4 v81, s[16:19], 0 offen offset:1024 nt lds
    v_mfma_f32_16x16x32_bf16 v[136:139], v[48:51], v[36:39], v[136:139]
    v_mul_f32 v116, v116, v12
    v_mul_f32 v117, v117, v12
    v_mul_f32 v118, v118, v12
    v_mul_f32 v119, v119, v12
    v_mul_f32 v148, v148, v13
    v_mul_f32 v149, v149, v13
    v_mul_f32 v150, v150, v13
    v_mul_f32 v151, v151, v13
    v_mfma_f32_16x16x32_bf16 v[108:111], v[52:55], v[32:35], v[108:111]
    v_mfma_f32_16x16x32_bf16 v[140:143], v[52:55], v[36:39], v[140:143]
    buffer_load_dwordx4 v82, s[16:19], 0 offen offset:2048 nt lds
    v_mul_f32 v120, v120, v12
    v_mul_f32 v121, v121, v12
    v_mul_f32 v122, v122, v12
    v_mul_f32 v123, v123, v12
    v_mul_f32 v152, v152, v13
    v_mul_f32 v153, v153, v13
    v_mul_f32 v154, v154, v13
    v_mul_f32 v155, v155, v13
    ds_write_b128 v76, v[104:107] offset:0
    ds_write_b128 v76, v[136:139] offset:2048
    v_mfma_f32_16x16x32_bf16 v[112:115], v[56:59], v[32:35], v[112:115]
    v_mfma_f32_16x16x32_bf16 v[144:147], v[56:59], v[36:39], v[144:147]
    buffer_load_dwordx4 v83, s[16:19], 0 offen offset:3072 nt lds
    v_mul_f32 v124, v124, v12
    v_mul_f32 v125, v125, v12
    v_mul_f32 v126, v126, v12
    v_mul_f32 v127, v127, v12
    v_mul_f32 v156, v156, v13
    v_mul_f32 v157, v157, v13
    v_mul_f32 v158, v158, v13
    v_mul_f32 v159, v159, v13
    ds_write_b128 v76, v[108:111] offset:1024
    ds_write_b128 v76, v[140:143] offset:3072
    v_mfma_f32_16x16x32_bf16 v[116:119], v[60:63], v[32:35], v[116:119]
    v_mfma_f32_16x16x32_bf16 v[148:151], v[60:63], v[36:39], v[148:151]
    s_mov_b32 m0, s67
    s_nop 0
    buffer_load_dwordx4 v80, s[16:19], s42 offen offset:0 nt lds
    v_add_u32 v80, 0x10000, v80
    v_mul_f32 v96, v96, v12
    v_mul_f32 v97, v97, v12
    v_mul_f32 v98, v98, v12
    v_mul_f32 v99, v99, v12
    v_mul_f32 v128, v128, v13
    v_mul_f32 v129, v129, v13
    v_mul_f32 v130, v130, v13
    v_mul_f32 v131, v131, v13
    ds_write_b128 v77, v[112:115] offset:0
    ds_write_b128 v77, v[144:147] offset:2048
    v_mfma_f32_16x16x32_bf16 v[120:123], v[64:67], v[32:35], v[120:123]
    v_mfma_f32_16x16x32_bf16 v[152:155], v[64:67], v[36:39], v[152:155]
    v_mul_f32 v100, v100, v12
    buffer_load_dwordx4 v81, s[16:19], s42 offen offset:1024 nt lds
    v_add_u32 v81, 0x10000, v81
    v_mul_f32 v101, v101, v12
    v_mul_f32 v102, v102, v12
    v_mul_f32 v103, v103, v12
    v_mul_f32 v132, v132, v13
    v_mul_f32 v133, v133, v13
    v_mul_f32 v134, v134, v13
    v_mul_f32 v135, v135, v13
    ds_write_b128 v77, v[116:119] offset:1024
    ds_write_b128 v77, v[148:151] offset:3072
    v_mfma_f32_16x16x32_bf16 v[124:127], v[68:71], v[32:35], v[124:127]
    v_mfma_f32_16x16x32_bf16 v[156:159], v[68:71], v[36:39], v[156:159]
    v_mfma_f32_16x16x32_bf16 v[96:99], v[40:43], v[32:35], v[96:99]
    buffer_load_dwordx4 v82, s[16:19], s42 offen offset:2048 nt lds
    v_add_u32 v82, 0x10000, v82
    v_mfma_f32_16x16x32_bf16 v[128:131], v[40:43], v[36:39], v[128:131]
    v_mfma_f32_16x16x32_bf16 v[100:103], v[44:47], v[32:35], v[100:103]
    v_mfma_f32_16x16x32_bf16 v[132:135], v[44:47], v[36:39], v[132:135]
    ds_write_b128 v78, v[120:123] offset:0
    ds_write_b128 v78, v[152:155] offset:2048
    s_nop 1
    ds_write_b128 v78, v[124:127] offset:1024
    ds_write_b128 v78, v[156:159] offset:3072
    buffer_load_dwordx4 v83, s[16:19], s42 offen offset:3072 nt lds
    v_add_u32 v83, 0x10000, v83
    s_waitcnt vmcnt(8) lgkmcnt(0)
    s_barrier
    ds_read_b128 v[192:195], v79 offset:0
    ds_read_b128 v[196:199], v79 offset:1024
    ds_read_b128 v[200:203], v79 offset:2048
    ds_read_b128 v[204:207], v79 offset:3072
    ds_read_b128 v[208:211], v79 offset:4096
    ds_read_b128 v[212:215], v79 offset:5120
    ds_read_b128 v[216:219], v79 offset:6144
    ds_read_b128 v[220:223], v79 offset:7168
    ds_read_b128 v[136:139], v79 offset:8192
    ds_read_b128 v[140:143], v79 offset:9216
    ds_read_b128 v[144:147], v79 offset:10240
    ds_read_b128 v[148:151], v79 offset:11264
    s_cmp_eq_u32 s45, 0
    s_cbranch_scc1 L_t1p
    buffer_load_dwordx4 v[176:179], v84, s[32:35], s41 offen sc1
    buffer_load_dwordx4 v[180:183], v84, s[32:35], s41 offen offset:256 sc1
    s_branch L_t1
L_t1p:
    s_mov_b32 exec_hi, 0
    buffer_store_dwordx4 v[224:227], v75, s[32:35], s41 offen sc1
    s_mov_b64 exec, -1
L_t1:
    v_mul_f32 v16, v240, v96
    v_mul_f32 v17, v240, v97
    v_mul_f32 v18, v240, v98
    v_mul_f32 v19, v240, v99
    v_mul_f32 v20, v240, v100
    v_mul_f32 v21, v240, v101
    v_mul_f32 v22, v240, v102
    v_mul_f32 v23, v240, v103
    v_mul_f32 v24, v241, v128
    v_mul_f32 v25, v241, v129
    v_mul_f32 v26, v241, v130
    v_mul_f32 v27, v241, v131
    v_mul_f32 v28, v241, v132
    v_mul_f32 v29, v241, v133
    v_mul_f32 v30, v241, v134
    v_mul_f32 v31, v241, v135
    s_waitcnt lgkmcnt(8)
    v_fma_f32 v16, v242, v192, v16
    v_fma_f32 v17, v242, v193, v17
    v_fma_f32 v18, v242, v194, v18
    v_fma_f32 v19, v242, v195, v19
    v_fma_f32 v20, v242, v196, v20
    v_fma_f32 v21, v242, v197, v21
    v_fma_f32 v22, v242, v198, v22
    v_fma_f32 v23, v242, v199, v23
    v_fma_f32 v24, v243, v200, v24
    v_fma_f32 v25, v243, v201, v25
    v_fma_f32 v26, v243, v202, v26
    v_fma_f32 v27, v243, v203, v27
    v_fma_f32 v28, v243, v204, v28
    v_fma_f32 v29, v243, v205, v29
    v_fma_f32 v30, v243, v206, v30
    v_fma_f32 v31, v243, v207, v31
    s_waitcnt lgkmcnt(0)
    ds_read_b64_tr_b16 v[40:41], v249 offset:0
    ds_read_b64_tr_b16 v[42:43], v249 offset:4096
    ds_read_b64_tr_b16 v[44:45], v255 offset:0
    ds_read_b64_tr_b16 v[46:47], v255 offset:4096
    ds_read_b64_tr_b16 v[48:49], v249 offset:16384
    ds_read_b64_tr_b16 v[50:51], v249 offset:20480
    ds_read_b64_tr_b16 v[52:53], v255 offset:16384
    ds_read_b64_tr_b16 v[54:55], v255 offset:20480
    ds_read_b64_tr_b16 v[56:57], v249 offset:32768
    ds_read_b64_tr_b16 v[58:59], v249 offset:36864
    ds_read_b64_tr_b16 v[60:61], v255 offset:32768
    ds_read_b64_tr_b16 v[62:63], v255 offset:36864
    ds_read_b64_tr_b16 v[64:65], v249 offset:49152
    ds_read_b64_tr_b16 v[66:67], v249 offset:53248
    ds_read_b64_tr_b16 v[68:69], v255 offset:49152
    ds_read_b64_tr_b16 v[70:71], v255 offset:53248
    v_fma_f32 v16, v244, v208, v16
    v_fma_f32 v17, v244, v209, v17
    v_fma_f32 v18, v244, v210, v18
    v_fma_f32 v19, v244, v211, v19
    v_fma_f32 v20, v244, v212, v20
    v_fma_f32 v21, v244, v213, v21
    v_fma_f32 v22, v244, v214, v22
    v_fma_f32 v23, v244, v215, v23
    v_fma_f32 v24, v245, v216, v24
    v_fma_f32 v25, v245, v217, v25
    v_fma_f32 v26, v245, v218, v26
    v_fma_f32 v27, v245, v219, v27
    v_fma_f32 v28, v245, v220, v28
    v_fma_f32 v29, v245, v221, v29
    v_fma_f32 v30, v245, v222, v30
    v_fma_f32 v31, v245, v223, v31
    v_fma_f32 v16, v246, v136, v16
    v_fma_f32 v17, v246, v137, v17
    v_fma_f32 v18, v246, v138, v18
    v_fma_f32 v19, v246, v139, v19
    v_fma_f32 v20, v246, v140, v20
    v_fma_f32 v21, v246, v141, v21
    v_fma_f32 v22, v246, v142, v22
    v_fma_f32 v23, v246, v143, v23
    v_fma_f32 v24, v247, v144, v24
    v_fma_f32 v25, v247, v145, v25
    v_fma_f32 v26, v247, v146, v26
    v_fma_f32 v27, v247, v147, v27
    v_fma_f32 v28, v247, v148, v28
    v_fma_f32 v29, v247, v149, v29
    v_fma_f32 v30, v247, v150, v30
    v_fma_f32 v31, v247, v151, v31
    s_waitcnt lgkmcnt(0)
    s_nop 0
    v_mfma_f32_16x16x32_bf16 v[16:19], v[40:43], a[0:3], v[16:19]
    v_mfma_f32_16x16x32_bf16 v[24:27], v[40:43], a[4:7], v[24:27]
    v_mfma_f32_16x16x32_bf16 v[20:23], v[44:47], a[0:3], v[20:23]
    v_mfma_f32_16x16x32_bf16 v[28:31], v[44:47], a[4:7], v[28:31]
    v_mfma_f32_16x16x32_bf16 v[16:19], v[48:51], a[16:19], v[16:19]
    v_mfma_f32_16x16x32_bf16 v[24:27], v[48:51], a[20:23], v[24:27]
    v_mfma_f32_16x16x32_bf16 v[20:23], v[52:55], a[16:19], v[20:23]
    v_mfma_f32_16x16x32_bf16 v[28:31], v[52:55], a[20:23], v[28:31]
    v_mfma_f32_16x16x32_bf16 v[16:19], v[56:59], a[32:35], v[16:19]
    v_mfma_f32_16x16x32_bf16 v[24:27], v[56:59], a[36:39], v[24:27]
    v_mfma_f32_16x16x32_bf16 v[20:23], v[60:63], a[32:35], v[20:23]
    v_mfma_f32_16x16x32_bf16 v[28:31], v[60:63], a[36:39], v[28:31]
    v_mfma_f32_16x16x32_bf16 v[16:19], v[64:67], a[48:51], v[16:19]
    v_mfma_f32_16x16x32_bf16 v[24:27], v[64:67], a[52:55], v[24:27]
    v_mfma_f32_16x16x32_bf16 v[20:23], v[68:71], a[48:51], v[20:23]
    v_mfma_f32_16x16x32_bf16 v[28:31], v[68:71], a[52:55], v[28:31]
    s_cmp_eq_u32 s45, 0
    s_cbranch_scc1 L_plast
    s_lshl_b32 s50, s40, 8
    s_add_u32 s50, s50, s2
    s_cmp_ge_u32 s50, 8
    s_cbranch_scc1 L_nocleanc
    s_movk_i32 s30, 0x100
    s_mov_b64 exec, 1
    buffer_store_byte v254, v251, s[28:31], 0 offen sc1
    s_mov_b64 exec, -1
L_nocleanc:
    buffer_load_dwordx4 v[160:163], v74, s[32:35], 0 offen offset:0 sc1
    buffer_load_dwordx4 v[164:167], v74, s[32:35], 0 offen offset:1024 sc1
    buffer_load_dwordx4 v[168:171], v74, s[32:35], 0 offen offset:2048 sc1
    buffer_load_dwordx4 v[172:175], v74, s[32:35], 0 offen offset:3072 sc1
    s_waitcnt vmcnt(6)
    s_barrier
    ds_read_b64_tr_b16 v[40:41], v249 offset:8192
    ds_read_b64_tr_b16 v[42:43], v249 offset:12288
    ds_read_b64_tr_b16 v[44:45], v255 offset:8192
    ds_read_b64_tr_b16 v[46:47], v255 offset:12288
    ds_read_b64_tr_b16 v[48:49], v249 offset:24576
    ds_read_b64_tr_b16 v[50:51], v249 offset:28672
    ds_read_b64_tr_b16 v[52:53], v255 offset:24576
    ds_read_b64_tr_b16 v[54:55], v255 offset:28672
    ds_read_b64_tr_b16 v[56:57], v249 offset:40960
    ds_read_b64_tr_b16 v[58:59], v249 offset:45056
    ds_read_b64_tr_b16 v[60:61], v255 offset:40960
    ds_read_b64_tr_b16 v[62:63], v255 offset:45056
    ds_read_b64_tr_b16 v[64:65], v249 offset:57344
    ds_read_b64_tr_b16 v[66:67], v249 offset:61440
    ds_read_b64_tr_b16 v[68:69], v255 offset:57344
    ds_read_b64_tr_b16 v[70:71], v255 offset:61440
    s_waitcnt vmcnt(4)
    v_xor_b32 v8, v176, v177
    v_xad_u32 v8, v8, v178, v85
    v_add_u32 v10, v179, v85
    v_xor_b32 v9, v180, v181
    v_xad_u32 v9, v9, v182, v85
    v_add_u32 v11, v183, v85
    v_or3_b32 v8, v8, v9, v10
    v_or_b32 v8, v8, v11
    v_cmp_ne_u32 vcc, 0, v8
    s_nop 1
    s_cmp_eq_u64 vcc, 0
    s_cselect_b32 s22, 1, 0
    s_waitcnt lgkmcnt(12)
    v_mfma_f32_16x16x32_bf16 v[16:19], v[40:43], a[8:11], v[16:19]
    v_max_f32 v8, v188, v176
    v_max_f32 v9, v189, v180
    v_mfma_f32_16x16x32_bf16 v[24:27], v[40:43], a[12:15], v[24:27]
    v_sub_f32 v228, v188, v8
    v_sub_f32 v230, v176, v8
    v_mfma_f32_16x16x32_bf16 v[20:23], v[44:47], a[8:11], v[20:23]
    v_sub_f32 v229, v189, v9
    v_sub_f32 v231, v180, v9
    v_mfma_f32_16x16x32_bf16 v[28:31], v[44:47], a[12:15], v[28:31]
    v_mul_f32 v228, s43, v228
    v_mul_f32 v229, s43, v229
    s_waitcnt lgkmcnt(8)
    v_mfma_f32_16x16x32_bf16 v[16:19], v[48:51], a[24:27], v[16:19]
    v_mul_f32 v230, s43, v230
    v_mul_f32 v231, s43, v231
    v_mfma_f32_16x16x32_bf16 v[24:27], v[48:51], a[28:31], v[24:27]
    v_exp_f32 v228, v228
    v_exp_f32 v229, v229
    v_mfma_f32_16x16x32_bf16 v[20:23], v[52:55], a[24:27], v[20:23]
    v_exp_f32 v230, v230
    v_exp_f32 v231, v231
    v_mfma_f32_16x16x32_bf16 v[28:31], v[52:55], a[28:31], v[28:31]
    v_mul_f32 v10, v228, v190
    v_mul_f32 v11, v229, v191
    s_waitcnt lgkmcnt(4)
    v_mfma_f32_16x16x32_bf16 v[16:19], v[56:59], a[40:43], v[16:19]
    v_fma_f32 v10, v230, v177, v10
    v_fma_f32 v11, v231, v181, v11
    v_mfma_f32_16x16x32_bf16 v[24:27], v[56:59], a[44:47], v[24:27]
    v_rcp_f32 v10, v10
    v_rcp_f32 v11, v11
    v_mfma_f32_16x16x32_bf16 v[20:23], v[60:63], a[40:43], v[20:23]
    s_nop 0
    v_mul_f32 v228, v228, v10
    v_mfma_f32_16x16x32_bf16 v[28:31], v[60:63], a[44:47], v[28:31]
    v_mul_f32 v230, v230, v10
    v_mul_f32 v229, v229, v11
    s_waitcnt lgkmcnt(0)
    v_mfma_f32_16x16x32_bf16 v[16:19], v[64:67], a[56:59], v[16:19]
    v_mul_f32 v231, v231, v11
    v_mfma_f32_16x16x32_bf16 v[24:27], v[64:67], a[60:63], v[24:27]
    v_mfma_f32_16x16x32_bf16 v[20:23], v[68:71], a[56:59], v[20:23]
    v_mfma_f32_16x16x32_bf16 v[28:31], v[68:71], a[60:63], v[28:31]
    s_cmp_eq_u32 s22, 0
    s_cbranch_scc1 L_nostat
    s_nop 2
L_own:
    v_and_b32 v16, 0xffffff00, v16
    v_and_b32 v17, 0xffffff00, v17
    v_and_b32 v18, 0xffffff00, v18
    v_and_b32 v19, 0xffffff00, v19
    v_mul_f32 v104, v228, v16
    v_mul_f32 v105, v228, v17
    v_mul_f32 v106, v228, v18
    v_mul_f32 v107, v228, v19
    v_and_b32 v24, 0xffffff00, v24
    v_and_b32 v25, 0xffffff00, v25
    v_and_b32 v26, 0xffffff00, v26
    v_and_b32 v27, 0xffffff00, v27
    v_mul_f32 v112, v229, v24
    v_mul_f32 v113, v229, v25
    v_mul_f32 v114, v229, v26
    v_mul_f32 v115, v229, v27
    v_and_b32 v20, 0xffffff00, v20
    v_and_b32 v21, 0xffffff00, v21
    v_and_b32 v22, 0xffffff00, v22
    v_and_b32 v23, 0xffffff00, v23
    v_mul_f32 v108, v228, v20
    v_mul_f32 v109, v228, v21
    v_mul_f32 v110, v228, v22
    v_mul_f32 v111, v228, v23
    v_and_b32 v28, 0xffffff00, v28
    v_and_b32 v29, 0xffffff00, v29
    v_and_b32 v30, 0xffffff00, v30
    v_and_b32 v31, 0xffffff00, v31
    v_mul_f32 v116, v229, v28
    v_mul_f32 v117, v229, v29
    v_mul_f32 v118, v229, v30
    v_mul_f32 v119, v229, v31
L_retry:
    s_waitcnt vmcnt(0)
    v_perm_b32 v32, v161, v160, s49
    v_perm_b32 v33, v163, v162, s60
    v_perm_b32 v34, v165, v164, s49
    v_perm_b32 v35, v167, v166, s60
    v_perm_b32 v36, v169, v168, s49
    v_perm_b32 v37, v171, v170, s60
    v_perm_b32 v38, v173, v172, s49
    v_perm_b32 v39, v175, v174, s60
    v_xad_u32 v32, v32, v33, v85
    v_xad_u32 v34, v34, v35, v85
    v_xad_u32 v36, v36, v37, v85
    v_xad_u32 v38, v38, v39, v85
    v_or3_b32 v32, v32, v34, v36
    v_or_b32 v32, v32, v38
    v_cmp_ne_u32 vcc, 0, v32
    s_nop 1
    s_cmp_eq_u64 vcc, 0
    s_cbranch_scc0 L_again
L_final:
    s_mov_b64 exec, 1
    buffer_store_dword v72, v73, s[32:35], 0 offen sc1
    s_mov_b64 exec, -1
    v_and_b32 v160, 0xffffff00, v160
    v_and_b32 v161, 0xffffff00, v161
    v_and_b32 v162, 0xffffff00, v162
    v_and_b32 v163, 0xffffff00, v163
    v_fma_f32 v104, v230, v160, v104
    v_fma_f32 v105, v230, v161, v105
    v_fma_f32 v106, v230, v162, v106
    v_fma_f32 v107, v230, v163, v107
    v_cvt_pk_bf16_f32 v32, v104, v105
    v_cvt_pk_bf16_f32 v33, v106, v107
    v_and_b32 v164, 0xffffff00, v164
    v_and_b32 v165, 0xffffff00, v165
    v_and_b32 v166, 0xffffff00, v166
    v_and_b32 v167, 0xffffff00, v167
    v_fma_f32 v108, v230, v164, v108
    v_fma_f32 v109, v230, v165, v109
    v_fma_f32 v110, v230, v166, v110
    v_fma_f32 v111, v230, v167, v111
    v_cvt_pk_bf16_f32 v34, v108, v109
    v_cvt_pk_bf16_f32 v35, v110, v111
    s_nop 0
    v_permlane16_swap_b32 v32, v34
    v_permlane16_swap_b32 v33, v35
    buffer_store_dwordx4 v[32:35], v2, s[36:39], 0 offen sc1
    v_and_b32 v168, 0xffffff00, v168
    v_and_b32 v169, 0xffffff00, v169
    v_and_b32 v170, 0xffffff00, v170
    v_and_b32 v171, 0xffffff00, v171
    v_fma_f32 v112, v231, v168, v112
    v_fma_f32 v113, v231, v169, v113
    v_fma_f32 v114, v231, v170, v114
    v_fma_f32 v115, v231, v171, v115
    v_cvt_pk_bf16_f32 v36, v112, v113
    v_cvt_pk_bf16_f32 v37, v114, v115
    v_and_b32 v172, 0xffffff00, v172
    v_and_b32 v173, 0xffffff00, v173
    v_and_b32 v174, 0xffffff00, v174
    v_and_b32 v175, 0xffffff00, v175
    v_fma_f32 v116, v231, v172, v116
    v_fma_f32 v117, v231, v173, v117
    v_fma_f32 v118, v231, v174, v118
    v_fma_f32 v119, v231, v175, v119
    v_cvt_pk_bf16_f32 v38, v116, v117
    v_cvt_pk_bf16_f32 v39, v118, v119
    s_nop 0
    v_permlane16_swap_b32 v36, v38
    v_permlane16_swap_b32 v37, v39
    buffer_store_dwordx4 v[36:39], v2, s[36:39], s41 offen sc1
    s_endpgm
L_again:
    s_cmp_eq_u32 s46, 0
    s_cbranch_scc1 L_giveup
    s_sub_u32 s46, s46, 1
    buffer_load_dwordx4 v[160:163], v74, s[32:35], 0 offen offset:0 sc1
    buffer_load_dwordx4 v[164:167], v74, s[32:35], 0 offen offset:1024 sc1
    buffer_load_dwordx4 v[168:171], v74, s[32:35], 0 offen offset:2048 sc1
    buffer_load_dwordx4 v[172:175], v74, s[32:35], 0 offen offset:3072 sc1
    s_branch L_retry
L_nostat:
    s_cmp_eq_u32 s46, 0
    s_cbranch_scc1 L_giveup
    s_sub_u32 s46, s46, 1
    buffer_load_dwordx4 v[176:179], v84, s[32:35], s41 offen sc1
    buffer_load_dwordx4 v[180:183], v84, s[32:35], s41 offen offset:256 sc1
    s_waitcnt vmcnt(0)
    v_xor_b32 v8, v176, v177
    v_xad_u32 v8, v8, v178, v85
    v_add_u32 v10, v179, v85
    v_xor_b32 v9, v180, v181
    v_xad_u32 v9, v9, v182, v85
    v_add_u32 v11, v183, v85
    v_or3_b32 v8, v8, v9, v10
    v_or_b32 v8, v8, v11
    v_cmp_ne_u32 vcc, 0, v8
    s_nop 1
    s_cmp_eq_u64 vcc, 0
    s_cbranch_scc0 L_nostat
    buffer_load_dwordx4 v[160:163], v74, s[32:35], 0 offen offset:0 sc1
    buffer_load_dwordx4 v[164:167], v74, s[32:35], 0 offen offset:1024 sc1
    buffer_load_dwordx4 v[168:171], v74, s[32:35], 0 offen offset:2048 sc1
    buffer_load_dwordx4 v[172:175], v74, s[32:35], 0 offen offset:3072 sc1
    v_max_f32 v8, v188, v176
    v_max_f32 v9, v189, v180
    v_sub_f32 v228, v188, v8
    v_sub_f32 v230, v176, v8
    v_sub_f32 v229, v189, v9
    v_sub_f32 v231, v180, v9
    v_mul_f32 v228, s43, v228
    v_mul_f32 v229, s43, v229
    v_mul_f32 v230, s43, v230
    v_mul_f32 v231, s43, v231
    v_exp_f32 v228, v228
    v_exp_f32 v229, v229
    v_exp_f32 v230, v230
    v_exp_f32 v231, v231
    v_mul_f32 v10, v228, v190
    v_mul_f32 v11, v229, v191
    v_fma_f32 v10, v230, v177, v10
    v_fma_f32 v11, v231, v181, v11
    v_rcp_f32 v10, v10
    v_rcp_f32 v11, v11
    s_nop 0
    v_mul_f32 v228, v228, v10
    v_mul_f32 v230, v230, v10
    v_mul_f32 v229, v229, v11
    v_mul_f32 v231, v231, v11
    s_branch L_own
L_giveup:
    s_waitcnt vmcnt(0)
    s_nop 4
    s_mov_b32 exec_hi, 0
    buffer_store_dwordx4 v[224:227], v75, s[32:35], s41 offen sc1
    s_mov_b64 exec, -1
    s_branch L_publish
L_plast:
    s_waitcnt vmcnt(0)
    s_barrier
    ds_read_b64_tr_b16 v[40:41], v249 offset:8192
    ds_read_b64_tr_b16 v[42:43], v249 offset:12288
    ds_read_b64_tr_b16 v[44:45], v255 offset:8192
    ds_read_b64_tr_b16 v[46:47], v255 offset:12288
    ds_read_b64_tr_b16 v[48:49], v249 offset:24576
    ds_read_b64_tr_b16 v[50:51], v249 offset:28672
    ds_read_b64_tr_b16 v[52:53], v255 offset:24576
    ds_read_b64_tr_b16 v[54:55], v255 offset:28672
    ds_read_b64_tr_b16 v[56:57], v249 offset:40960
    ds_read_b64_tr_b16 v[58:59], v249 offset:45056
    ds_read_b64_tr_b16 v[60:61], v255 offset:40960
    ds_read_b64_tr_b16 v[62:63], v255 offset:45056
    ds_read_b64_tr_b16 v[64:65], v249 offset:57344
    ds_read_b64_tr_b16 v[66:67], v249 offset:61440
    ds_read_b64_tr_b16 v[68:69], v255 offset:57344
    ds_read_b64_tr_b16 v[70:71], v255 offset:61440
    s_waitcnt lgkmcnt(12)
    v_mfma_f32_16x16x32_bf16 v[16:19], v[40:43], a[8:11], v[16:19]
    v_mfma_f32_16x16x32_bf16 v[24:27], v[40:43], a[12:15], v[24:27]
    v_mfma_f32_16x16x32_bf16 v[20:23], v[44:47], a[8:11], v[20:23]
    v_mfma_f32_16x16x32_bf16 v[28:31], v[44:47], a[12:15], v[28:31]
    s_waitcnt lgkmcnt(8)
    v_mfma_f32_16x16x32_bf16 v[16:19], v[48:51], a[24:27], v[16:19]
    v_mfma_f32_16x16x32_bf16 v[24:27], v[48:51], a[28:31], v[24:27]
    v_mfma_f32_16x16x32_bf16 v[20:23], v[52:55], a[24:27], v[20:23]
    v_mfma_f32_16x16x32_bf16 v[28:31], v[52:55], a[28:31], v[28:31]
    s_waitcnt lgkmcnt(4)
    v_mfma_f32_16x16x32_bf16 v[16:19], v[56:59], a[40:43], v[16:19]
    v_mfma_f32_16x16x32_bf16 v[24:27], v[56:59], a[44:47], v[24:27]
    v_mfma_f32_16x16x32_bf16 v[20:23], v[60:63], a[40:43], v[20:23]
    v_mfma_f32_16x16x32_bf16 v[28:31], v[60:63], a[44:47], v[28:31]
    s_waitcnt lgkmcnt(0)
    v_mfma_f32_16x16x32_bf16 v[16:19], v[64:67], a[56:59], v[16:19]
    v_mfma_f32_16x16x32_bf16 v[24:27], v[64:67], a[60:63], v[24:27]
    v_mfma_f32_16x16x32_bf16 v[20:23], v[68:71], a[56:59], v[20:23]
    v_mfma_f32_16x16x32_bf16 v[28:31], v[68:71], a[60:63], v[28:31]
    s_nop 4
L_publish:
    v_bfi_b32 v192, s48, v184, v16
    v_bfi_b32 v193, s48, v185, v17
    v_bfi_b32 v194, s48, v186, v18
    v_bfi_b32 v195, s48, v187, v19
    buffer_store_dwordx4 v[192:195], v75, s[32:35], 0 offen offset:0 sc1
    v_bfi_b32 v200, s48, v184, v24
    v_bfi_b32 v201, s48, v185, v25
    v_bfi_b32 v202, s48, v186, v26
    v_bfi_b32 v203, s48, v187, v27
    buffer_store_dwordx4 v[200:203], v75, s[32:35], 0 offen offset:2048 sc1
    v_bfi_b32 v196, s48, v184, v20
    v_bfi_b32 v197, s48, v185, v21
    v_bfi_b32 v198, s48, v186, v22
    v_bfi_b32 v199, s48, v187, v23
    buffer_store_dwordx4 v[196:199], v75, s[32:35], 0 offen offset:1024 sc1
    v_bfi_b32 v204, s48, v184, v28
    v_bfi_b32 v205, s48, v185, v29
    v_bfi_b32 v206, s48, v186, v30
    v_bfi_b32 v207, s48, v187, v31
    buffer_store_dwordx4 v[204:207], v75, s[32:35], 0 offen offset:3072 sc1
    s_lshl_b32 s50, s40, 8
    s_add_u32 s50, s50, s2
    s_cmp_ge_u32 s50, 8
    s_cbranch_scc1 L_nocleanp
    s_movk_i32 s30, 0x100
    s_mov_b64 exec, 1
    buffer_store_byte v254, v251, s[28:31], 0 offen sc1
    s_mov_b64 exec, -1
L_nocleanp:
    s_waitcnt vmcnt(0)
    buffer_load_dwordx4 v[176:179], v84, s[32:35], s41 offen sc1
    buffer_load_dwordx4 v[180:183], v84, s[32:35], s41 offen offset:256 sc1
    s_waitcnt vmcnt(0)
    v_xor_b32 v8, v176, v177
    v_xad_u32 v8, v8, v178, v85
    v_add_u32 v10, v179, v85
    v_xor_b32 v9, v180, v181
    v_xad_u32 v9, v9, v182, v85
    v_add_u32 v11, v183, v85
    v_or3_b32 v8, v8, v9, v10
    v_or_b32 v8, v8, v11
    v_cmp_ne_u32 vcc, 0, v8
    s_nop 1
    s_cmp_eq_u64 vcc, 0
    s_cbranch_scc0 L_fin
    buffer_load_dwordx4 v[160:163], v74, s[32:35], 0 offen offset:0 sc1
    buffer_load_dwordx4 v[164:167], v74, s[32:35], 0 offen offset:1024 sc1
    buffer_load_dwordx4 v[168:171], v74, s[32:35], 0 offen offset:2048 sc1
    buffer_load_dwordx4 v[172:175], v74, s[32:35], 0 offen offset:3072 sc1
    s_waitcnt vmcnt(0)
    v_perm_b32 v32, v161, v160, s49
    v_perm_b32 v33, v163, v162, s60
    v_perm_b32 v34, v165, v164, s49
    v_perm_b32 v35, v167, v166, s60
    v_perm_b32 v36, v169, v168, s49
    v_perm_b32 v37, v171, v170, s60
    v_perm_b32 v38, v173, v172, s49
    v_perm_b32 v39, v175, v174, s60
    v_xad_u32 v32, v32, v33, v85
    v_xad_u32 v34, v34, v35, v85
    v_xad_u32 v36, v36, v37, v85
    v_xad_u32 v38, v38, v39, v85
    v_or3_b32 v32, v32, v34, v36
    v_or_b32 v32, v32, v38
    v_cmp_ne_u32 vcc, 0, v32
    s_nop 1
    s_cmp_eq_u64 vcc, 0
    s_cbranch_scc0 L_fin
    s_cmp_lg_u32 s45, 0
    s_cbranch_scc1 L_combine
    v_swap_b32 v16, v160
    v_swap_b32 v17, v161
    v_swap_b32 v18, v162
    v_swap_b32 v19, v163
    v_swap_b32 v20, v164
    v_swap_b32 v21, v165
    v_swap_b32 v22, v166
    v_swap_b32 v23, v167
    v_swap_b32 v24, v168
    v_swap_b32 v25, v169
    v_swap_b32 v26, v170
    v_swap_b32 v27, v171
    v_swap_b32 v28, v172
    v_swap_b32 v29, v173
    v_swap_b32 v30, v174
    v_swap_b32 v31, v175
    v_swap_b32 v188, v176
    v_swap_b32 v190, v177
    v_swap_b32 v189, v180
    v_swap_b32 v191, v181
L_combine:
    v_max_f32 v8, v188, v176
    v_max_f32 v9, v189, v180
    v_sub_f32 v228, v188, v8
    v_sub_f32 v230, v176, v8
    v_sub_f32 v229, v189, v9
    v_sub_f32 v231, v180, v9
    v_mul_f32 v228, s43, v228
    v_mul_f32 v229, s43, v229
    v_mul_f32 v230, s43, v230
    v_mul_f32 v231, s43, v231
    v_exp_f32 v228, v228
    v_exp_f32 v229, v229
    v_exp_f32 v230, v230
    v_exp_f32 v231, v231
    v_mul_f32 v10, v228, v190
    v_mul_f32 v11, v229, v191
    v_fma_f32 v10, v230, v177, v10
    v_fma_f32 v11, v231, v181, v11
    v_rcp_f32 v10, v10
    v_rcp_f32 v11, v11
    s_nop 0
    v_mul_f32 v228, v228, v10
    v_mul_f32 v230, v230, v10
    v_mul_f32 v229, v229, v11
    v_mul_f32 v231, v231, v11
    v_and_b32 v16, 0xffffff00, v16
    v_and_b32 v17, 0xffffff00, v17
    v_and_b32 v18, 0xffffff00, v18
    v_and_b32 v19, 0xffffff00, v19
    v_mul_f32 v104, v228, v16
    v_mul_f32 v105, v228, v17
    v_mul_f32 v106, v228, v18
    v_mul_f32 v107, v228, v19
    v_and_b32 v20, 0xffffff00, v20
    v_and_b32 v21, 0xffffff00, v21
    v_and_b32 v22, 0xffffff00, v22
    v_and_b32 v23, 0xffffff00, v23
    v_mul_f32 v108, v228, v20
    v_mul_f32 v109, v228, v21
    v_mul_f32 v110, v228, v22
    v_mul_f32 v111, v228, v23
    v_and_b32 v24, 0xffffff00, v24
    v_and_b32 v25, 0xffffff00, v25
    v_and_b32 v26, 0xffffff00, v26
    v_and_b32 v27, 0xffffff00, v27
    v_mul_f32 v112, v229, v24
    v_mul_f32 v113, v229, v25
    v_mul_f32 v114, v229, v26
    v_mul_f32 v115, v229, v27
    v_and_b32 v28, 0xffffff00, v28
    v_and_b32 v29, 0xffffff00, v29
    v_and_b32 v30, 0xffffff00, v30
    v_and_b32 v31, 0xffffff00, v31
    v_mul_f32 v116, v229, v28
    v_mul_f32 v117, v229, v29
    v_mul_f32 v118, v229, v30
    v_mul_f32 v119, v229, v31
    s_branch L_final
L_fin:
L_end:
    s_endpgm
    .p2align 6
L_bodyK0:
    s_waitcnt vmcnt(8)
    ds_read_b128 v[40:43], v84 offset:0
    ds_read_b128 v[44:47], v84 offset:4096
    ds_read_b128 v[48:51], v85 offset:0
    ds_read_b128 v[52:55], v85 offset:4096
    ds_read_b128 v[56:59], v86 offset:0
    ds_read_b128 v[60:63], v86 offset:4096
    ds_read_b128 v[64:67], v87 offset:0
    ds_read_b128 v[68:71], v87 offset:4096
    v_cmp_lt_u32 vcc, v254, v253
    v_add_u32 v254, 2, v254
    s_mov_b64 exec, 1
    buffer_store_byte v254, v251, s[28:31], 0 offen
    s_mov_b64 exec, -1
    buffer_load_ubyte v253, v252, s[28:31], 0 offen nt
    s_bcnt1_i32_b32 s50, vcc_lo
    s_cmp_ge_u32 s50, 8
    s_cselect_b64 vcc, -1, 0
    s_waitcnt lgkmcnt(0)
    s_mov_b32 m0, s64
    s_cbranch_vccnz L_w33
    s_waitcnt vmcnt(7)
L_w33:
    s_waitcnt vmcnt(8)
    buffer_load_dwordx4 v80, s[16:19], 0 offen offset:0 nt lds
    v_mfma_f32_16x16x32_bf16 v[16:19], v[40:43], v[160:163], 0
    v_mfma_f32_16x16x32_bf16 v[20:23], v[40:43], v[176:179], 0
    v_mfma_f32_16x16x32_bf16 v[24:27], v[44:47], v[160:163], 0
    v_mfma_f32_16x16x32_bf16 v[28:31], v[44:47], v[176:179], 0
    v_mfma_f32_16x16x32_bf16 v[16:19], v[48:51], v[164:167], v[16:19]
    v_mfma_f32_16x16x32_bf16 v[20:23], v[48:51], v[180:183], v[20:23]
    v_mfma_f32_16x16x32_bf16 v[24:27], v[52:55], v[164:167], v[24:27]
    v_mfma_f32_16x16x32_bf16 v[28:31], v[52:55], v[180:183], v[28:31]
    s_cbranch_vccnz L_w34
    s_waitcnt vmcnt(6)
L_w34:
    s_waitcnt vmcnt(7)
    buffer_load_dwordx4 v81, s[16:19], 0 offen offset:1024 nt lds
    v_mfma_f32_16x16x32_bf16 v[16:19], v[56:59], v[168:171], v[16:19]
    v_mfma_f32_16x16x32_bf16 v[20:23], v[56:59], v[184:187], v[20:23]
    v_mfma_f32_16x16x32_bf16 v[24:27], v[60:63], v[168:171], v[24:27]
    v_mfma_f32_16x16x32_bf16 v[28:31], v[60:63], v[184:187], v[28:31]
    v_mfma_f32_16x16x32_bf16 v[16:19], v[64:67], v[172:175], v[16:19]
    v_mfma_f32_16x16x32_bf16 v[20:23], v[64:67], v[188:191], v[20:23]
    v_mfma_f32_16x16x32_bf16 v[24:27], v[68:71], v[172:175], v[24:27]
    s_cbranch_vccnz L_w35
    s_waitcnt vmcnt(6)
L_w35:
    s_waitcnt vmcnt(7)
    buffer_load_dwordx4 v82, s[16:19], 0 offen offset:2048 nt lds
    v_mfma_f32_16x16x32_bf16 v[28:31], v[68:71], v[188:191], v[28:31]
    s_nop 7
    v_max3_f32 v8, v16, v17, v18
    v_max3_f32 v8, v8, v19, v24
    v_max3_f32 v8, v8, v25, v26
    v_max_f32 v8, v8, v27
    v_max3_f32 v9, v20, v21, v22
    v_max3_f32 v9, v9, v23, v28
    v_max3_f32 v9, v9, v29, v30
    v_max_f32 v9, v9, v31
    s_nop 1
    s_cbranch_vccnz L_w36
    s_waitcnt vmcnt(6)
L_w36:
    s_waitcnt vmcnt(7)
    buffer_load_dwordx4 v83, s[16:19], 0 offen offset:3072 nt lds
    v_permlane32_swap_b32 v8, v9
    v_max_f32 v10, v8, v9
    v_mov_b32 v11, v10
    s_nop 1
    v_permlane16_swap_b32 v10, v11
    v_max3_f32 v10, v10, v11, v4
    v_mul_f32 v14, s43, v10
    v_mul_f32 v15, s43, v10
    v_sub_f32 v7, v4, v10
    v_mov_b32 v4, v10
    v_permlane32_swap_b32 v14, v15
    v_mul_f32 v7, s43, v7
    v_exp_f32 v7, v7
    v_fma_f32 v16, v16, s43, -v14
    v_fma_f32 v17, v17, s43, -v14
    v_fma_f32 v18, v18, s43, -v14
    v_fma_f32 v19, v19, s43, -v14
    v_fma_f32 v24, v24, s43, -v14
    v_fma_f32 v25, v25, s43, -v14
    v_fma_f32 v26, v26, s43, -v14
    v_add_u32 v3, 1, v254
    s_mov_b64 exec, 1
    buffer_store_byte v3, v251, s[28:31], 0 offen
    s_mov_b64 exec, -1
    s_mov_b32 m0, s65
    s_cbranch_vccnz L_w37
    s_waitcnt vmcnt(7)
L_w37:
    s_waitcnt vmcnt(8)
    buffer_load_dwordx4 v80, s[16:19], s42 offen offset:0 nt lds
    v_add_u32 v80, 0x10000, v80
    v_fma_f32 v27, v27, s43, -v14
    v_fma_f32 v20, v20, s43, -v15
    v_fma_f32 v21, v21, s43, -v15
    v_fma_f32 v22, v22, s43, -v15
    v_fma_f32 v23, v23, s43, -v15
    v_fma_f32 v28, v28, s43, -v15
    v_fma_f32 v29, v29, s43, -v15
    v_fma_f32 v30, v30, s43, -v15
    v_fma_f32 v31, v31, s43, -v15
    v_exp_f32 v16, v16
    v_exp_f32 v17, v17
    v_exp_f32 v18, v18
    v_exp_f32 v19, v19
    v_exp_f32 v24, v24
    v_exp_f32 v25, v25
    v_exp_f32 v26, v26
    s_cbranch_vccnz L_w38
    s_waitcnt vmcnt(5)
L_w38:
    s_waitcnt vmcnt(6)
    buffer_load_dwordx4 v81, s[16:19], s42 offen offset:1024 nt lds
    v_add_u32 v81, 0x10000, v81
    v_exp_f32 v27, v27
    v_exp_f32 v20, v20
    v_exp_f32 v21, v21
    v_exp_f32 v22, v22
    v_exp_f32 v23, v23
    v_exp_f32 v28, v28
    v_exp_f32 v29, v29
    v_exp_f32 v30, v30
    v_exp_f32 v31, v31
    v_add_f32 v8, v16, v17
    v_add_f32 v10, v18, v19
    v_add_f32 v8, v8, v24
    s_cbranch_vccnz L_w39
    s_waitcnt vmcnt(5)
L_w39:
    s_waitcnt vmcnt(6)
    buffer_load_dwordx4 v82, s[16:19], s42 offen offset:2048 nt lds
    v_add_u32 v82, 0x10000, v82
    v_add_f32 v10, v10, v25
    v_add_f32 v8, v8, v26
    v_add_f32 v10, v10, v27
    v_add_f32 v8, v8, v10
    v_add_f32 v9, v20, v21
    v_add_f32 v11, v22, v23
    v_add_f32 v9, v9, v28
    v_add_f32 v11, v11, v29
    v_add_f32 v9, v9, v30
    v_add_f32 v11, v11, v31
    v_add_f32 v9, v9, v11
    v_cvt_pk_bf16_f32 v32, v16, v17
    v_cvt_pk_bf16_f32 v33, v18, v19
    v_cvt_pk_bf16_f32 v34, v24, v25
    v_cvt_pk_bf16_f32 v35, v26, v27
    v_cvt_pk_bf16_f32 v36, v20, v21
    v_cvt_pk_bf16_f32 v37, v22, v23
    v_cvt_pk_bf16_f32 v38, v28, v29
    v_cvt_pk_bf16_f32 v39, v30, v31
    v_permlane32_swap_b32 v8, v9
    v_add_f32 v8, v8, v9
    v_fma_f32 v6, v6, v7, v8
    s_cbranch_vccnz L_w40
    s_waitcnt vmcnt(5)
L_w40:
    s_waitcnt vmcnt(6)
    buffer_load_dwordx4 v83, s[16:19], s42 offen offset:3072 nt lds
    v_add_u32 v83, 0x10000, v83
    s_setpc_b64 s[68:69]
    .p2align 6
L_bodyV0:
    s_waitcnt vmcnt(8)
    ds_read_b64_tr_b16 v[40:41], v88 offset:0
    ds_read_b64_tr_b16 v[42:43], v88 offset:4096
    ds_read_b64_tr_b16 v[44:45], v89 offset:0
    ds_read_b64_tr_b16 v[46:47], v89 offset:4096
    ds_read_b64_tr_b16 v[48:49], v90 offset:0
    ds_read_b64_tr_b16 v[50:51], v90 offset:4096
    ds_read_b64_tr_b16 v[52:53], v91 offset:0
    ds_read_b64_tr_b16 v[54:55], v91 offset:4096
    ds_read_b64_tr_b16 v[56:57], v92 offset:0
    ds_read_b64_tr_b16 v[58:59], v92 offset:4096
    ds_read_b64_tr_b16 v[60:61], v93 offset:0
    ds_read_b64_tr_b16 v[62:63], v93 offset:4096
    ds_read_b64_tr_b16 v[64:65], v94 offset:0
    ds_read_b64_tr_b16 v[66:67], v94 offset:4096
    ds_read_b64_tr_b16 v[68:69], v95 offset:0
    ds_read_b64_tr_b16 v[70:71], v95 offset:4096
    v_cmp_lt_u32 vcc, v254, v253
    v_add_u32 v254, 2, v254
    s_mov_b64 exec, 1
    buffer_store_byte v254, v251, s[28:31], 0 offen
    s_mov_b64 exec, -1
    buffer_load_ubyte v253, v252, s[28:31], 0 offen nt
    s_bcnt1_i32_b32 s50, vcc_lo
    s_cmp_ge_u32 s50, 8
    s_cselect_b64 vcc, -1, 0
    v_permlane32_swap_b32 v12, v13
    v_mul_f32 v96, v96, v12
    v_mul_f32 v97, v97, v12
    v_mul_f32 v98, v98, v12
    v_mul_f32 v99, v99, v12
    v_mul_f32 v128, v128, v13
    v_mul_f32 v129, v129, v13
    v_mul_f32 v130, v130, v13
    v_mul_f32 v131, v131, v13
    s_waitcnt lgkmcnt(0)
    s_mov_b32 m0, s64
    s_cbranch_vccnz L_w41
    s_waitcnt vmcnt(7)
L_w41:
    s_waitcnt vmcnt(8)
    buffer_load_dwordx4 v80, s[16:19], 0 offen offset:0 nt lds
    v_mul_f32 v100, v100, v12
    v_mul_f32 v101, v101, v12
    v_mul_f32 v102, v102, v12
    v_mul_f32 v103, v103, v12
    v_mul_f32 v132, v132, v13
    v_mul_f32 v133, v133, v13
    v_mul_f32 v134, v134, v13
    v_mul_f32 v135, v135, v13
    v_mul_f32 v104, v104, v12
    v_mul_f32 v105, v105, v12
    v_mul_f32 v106, v106, v12
    v_mul_f32 v107, v107, v12
    v_mul_f32 v136, v136, v13
    v_mul_f32 v137, v137, v13
    v_mul_f32 v138, v138, v13
    s_cbranch_vccnz L_w42
    s_waitcnt vmcnt(6)
L_w42:
    s_waitcnt vmcnt(7)
    buffer_load_dwordx4 v81, s[16:19], 0 offen offset:1024 nt lds
    v_mul_f32 v139, v139, v13
    v_mfma_f32_16x16x32_bf16 v[96:99], v[40:43], v[32:35], v[96:99]
    v_mfma_f32_16x16x32_bf16 v[128:131], v[40:43], v[36:39], v[128:131]
    v_mul_f32 v108, v108, v12
    v_mul_f32 v109, v109, v12
    v_mul_f32 v110, v110, v12
    v_mul_f32 v111, v111, v12
    v_mul_f32 v140, v140, v13
    v_mul_f32 v141, v141, v13
    v_mul_f32 v142, v142, v13
    v_mul_f32 v143, v143, v13
    s_cbranch_vccnz L_w43
    s_waitcnt vmcnt(6)
L_w43:
    s_waitcnt vmcnt(7)
    buffer_load_dwordx4 v82, s[16:19], 0 offen offset:2048 nt lds
    v_mfma_f32_16x16x32_bf16 v[100:103], v[44:47], v[32:35], v[100:103]
    v_mfma_f32_16x16x32_bf16 v[132:135], v[44:47], v[36:39], v[132:135]
    v_mul_f32 v112, v112, v12
    v_mul_f32 v113, v113, v12
    v_mul_f32 v114, v114, v12
    v_mul_f32 v115, v115, v12
    v_mul_f32 v144, v144, v13
    v_mul_f32 v145, v145, v13
    v_mul_f32 v146, v146, v13
    v_mul_f32 v147, v147, v13
    v_mfma_f32_16x16x32_bf16 v[104:107], v[48:51], v[32:35], v[104:107]
    s_cbranch_vccnz L_w44
    s_waitcnt vmcnt(6)
L_w44:
    s_waitcnt vmcnt(7)
    buffer_load_dwordx4 v83, s[16:19], 0 offen offset:3072 nt lds
    v_mfma_f32_16x16x32_bf16 v[136:139], v[48:51], v[36:39], v[136:139]
    v_mul_f32 v116, v116, v12
    v_mul_f32 v117, v117, v12
    v_mul_f32 v118, v118, v12
    v_mul_f32 v119, v119, v12
    v_mul_f32 v148, v148, v13
    v_mul_f32 v149, v149, v13
    v_mul_f32 v150, v150, v13
    v_mul_f32 v151, v151, v13
    v_mfma_f32_16x16x32_bf16 v[108:111], v[52:55], v[32:35], v[108:111]
    v_add_u32 v3, 1, v254
    s_mov_b64 exec, 1
    buffer_store_byte v3, v251, s[28:31], 0 offen
    s_mov_b64 exec, -1
    s_mov_b32 m0, s65
    s_cbranch_vccnz L_w45
    s_waitcnt vmcnt(7)
L_w45:
    s_waitcnt vmcnt(8)
    buffer_load_dwordx4 v80, s[16:19], s42 offen offset:0 nt lds
    v_add_u32 v80, 0x10000, v80
    v_mfma_f32_16x16x32_bf16 v[140:143], v[52:55], v[36:39], v[140:143]
    v_mul_f32 v120, v120, v12
    v_mul_f32 v121, v121, v12
    v_mul_f32 v122, v122, v12
    v_mul_f32 v123, v123, v12
    v_mul_f32 v152, v152, v13
    v_mul_f32 v153, v153, v13
    v_mul_f32 v154, v154, v13
    v_mul_f32 v155, v155, v13
    v_mfma_f32_16x16x32_bf16 v[112:115], v[56:59], v[32:35], v[112:115]
    s_cbranch_vccnz L_w46
    s_waitcnt vmcnt(5)
L_w46:
    s_waitcnt vmcnt(6)
    buffer_load_dwordx4 v81, s[16:19], s42 offen offset:1024 nt lds
    v_add_u32 v81, 0x10000, v81
    v_mfma_f32_16x16x32_bf16 v[144:147], v[56:59], v[36:39], v[144:147]
    v_mul_f32 v124, v124, v12
    v_mul_f32 v125, v125, v12
    v_mul_f32 v126, v126, v12
    v_mul_f32 v127, v127, v12
    v_mul_f32 v156, v156, v13
    v_mul_f32 v157, v157, v13
    v_mul_f32 v158, v158, v13
    v_mul_f32 v159, v159, v13
    v_mfma_f32_16x16x32_bf16 v[116:119], v[60:63], v[32:35], v[116:119]
    v_mfma_f32_16x16x32_bf16 v[148:151], v[60:63], v[36:39], v[148:151]
    s_cbranch_vccnz L_w47
    s_waitcnt vmcnt(5)
L_w47:
    s_waitcnt vmcnt(6)
    buffer_load_dwordx4 v82, s[16:19], s42 offen offset:2048 nt lds
    v_add_u32 v82, 0x10000, v82
    v_mfma_f32_16x16x32_bf16 v[120:123], v[64:67], v[32:35], v[120:123]
    v_mfma_f32_16x16x32_bf16 v[152:155], v[64:67], v[36:39], v[152:155]
    v_mfma_f32_16x16x32_bf16 v[124:127], v[68:71], v[32:35], v[124:127]
    v_mfma_f32_16x16x32_bf16 v[156:159], v[68:71], v[36:39], v[156:159]
    s_cbranch_vccnz L_w48
    s_waitcnt vmcnt(5)
L_w48:
    s_waitcnt vmcnt(6)
    buffer_load_dwordx4 v83, s[16:19], s42 offen offset:3072 nt lds
    v_add_u32 v83, 0x10000, v83
    s_setpc_b64 s[68:69]
    .p2align 6
L_bodyK1:
    s_waitcnt vmcnt(8)
    ds_read_b128 v[40:43], v84 offset:8192
    ds_read_b128 v[44:47], v84 offset:12288
    ds_read_b128 v[48:51], v85 offset:8192
    ds_read_b128 v[52:55], v85 offset:12288
    ds_read_b128 v[56:59], v86 offset:8192
    ds_read_b128 v[60:63], v86 offset:12288
    ds_read_b128 v[64:67], v87 offset:8192
    ds_read_b128 v[68:71], v87 offset:12288
    v_cmp_lt_u32 vcc, v254, v253
    v_add_u32 v254, 2, v254
    s_mov_b64 exec, 1
    buffer_store_byte v254, v251, s[28:31], 0 offen
    s_mov_b64 exec, -1
    buffer_load_ubyte v253, v252, s[28:31], 0 offen nt
    s_bcnt1_i32_b32 s50, vcc_lo
    s_cmp_ge_u32 s50, 8
    s_cselect_b64 vcc, -1, 0
    s_waitcnt lgkmcnt(0)
    s_mov_b32 m0, s66
    s_cbranch_vccnz L_w49
    s_waitcnt vmcnt(7)
L_w49:
    s_waitcnt vmcnt(8)
    buffer_load_dwordx4 v80, s[16:19], 0 offen offset:0 nt lds
    v_mfma_f32_16x16x32_bf16 v[16:19], v[40:43], v[160:163], 0
    v_mfma_f32_16x16x32_bf16 v[20:23], v[40:43], v[176:179], 0
    v_mfma_f32_16x16x32_bf16 v[24:27], v[44:47], v[160:163], 0
    v_mfma_f32_16x16x32_bf16 v[28:31], v[44:47], v[176:179], 0
    v_mfma_f32_16x16x32_bf16 v[16:19], v[48:51], v[164:167], v[16:19]
    v_mfma_f32_16x16x32_bf16 v[20:23], v[48:51], v[180:183], v[20:23]
    v_mfma_f32_16x16x32_bf16 v[24:27], v[52:55], v[164:167], v[24:27]
    v_mfma_f32_16x16x32_bf16 v[28:31], v[52:55], v[180:183], v[28:31]
    s_cbranch_vccnz L_w50
    s_waitcnt vmcnt(6)
L_w50:
    s_waitcnt vmcnt(7)
    buffer_load_dwordx4 v81, s[16:19], 0 offen offset:1024 nt lds
    v_mfma_f32_16x16x32_bf16 v[16:19], v[56:59], v[168:171], v[16:19]
    v_mfma_f32_16x16x32_bf16 v[20:23], v[56:59], v[184:187], v[20:23]
    v_mfma_f32_16x16x32_bf16 v[24:27], v[60:63], v[168:171], v[24:27]
    v_mfma_f32_16x16x32_bf16 v[28:31], v[60:63], v[184:187], v[28:31]
    v_mfma_f32_16x16x32_bf16 v[16:19], v[64:67], v[172:175], v[16:19]
    v_mfma_f32_16x16x32_bf16 v[20:23], v[64:67], v[188:191], v[20:23]
    v_mfma_f32_16x16x32_bf16 v[24:27], v[68:71], v[172:175], v[24:27]
    s_cbranch_vccnz L_w51
    s_waitcnt vmcnt(6)
L_w51:
    s_waitcnt vmcnt(7)
    buffer_load_dwordx4 v82, s[16:19], 0 offen offset:2048 nt lds
    v_mfma_f32_16x16x32_bf16 v[28:31], v[68:71], v[188:191], v[28:31]
    s_nop 7
    v_max3_f32 v8, v16, v17, v18
    v_max3_f32 v8, v8, v19, v24
    v_max3_f32 v8, v8, v25, v26
    v_max_f32 v8, v8, v27
    v_max3_f32 v9, v20, v21, v22
    v_max3_f32 v9, v9, v23, v28
    v_max3_f32 v9, v9, v29, v30
    v_max_f32 v9, v9, v31
    s_nop 1
    s_cbranch_vccnz L_w52
    s_waitcnt vmcnt(6)
L_w52:
    s_waitcnt vmcnt(7)
    buffer_load_dwordx4 v83, s[16:19], 0 offen offset:3072 nt lds
    v_permlane32_swap_b32 v8, v9
    v_max_f32 v10, v8, v9
    v_mov_b32 v11, v10
    s_nop 1
    v_permlane16_swap_b32 v10, v11
    v_max3_f32 v10, v10, v11, v4
    v_mul_f32 v14, s43, v10
    v_mul_f32 v15, s43, v10
    v_sub_f32 v7, v4, v10
    v_mov_b32 v4, v10
    v_permlane32_swap_b32 v14, v15
    v_mul_f32 v7, s43, v7
    v_exp_f32 v7, v7
    v_fma_f32 v16, v16, s43, -v14
    v_fma_f32 v17, v17, s43, -v14
    v_fma_f32 v18, v18, s43, -v14
    v_fma_f32 v19, v19, s43, -v14
    v_fma_f32 v24, v24, s43, -v14
    v_fma_f32 v25, v25, s43, -v14
    v_fma_f32 v26, v26, s43, -v14
    v_add_u32 v3, 1, v254
    s_mov_b64 exec, 1
    buffer_store_byte v3, v251, s[28:31], 0 offen
    s_mov_b64 exec, -1
    s_mov_b32 m0, s67
    s_cbranch_vccnz L_w53
    s_waitcnt vmcnt(7)
L_w53:
    s_waitcnt vmcnt(8)
    buffer_load_dwordx4 v80, s[16:19], s42 offen offset:0 nt lds
    v_add_u32 v80, 0x10000, v80
    v_fma_f32 v27, v27, s43, -v14
    v_fma_f32 v20, v20, s43, -v15
    v_fma_f32 v21, v21, s43, -v15
    v_fma_f32 v22, v22, s43, -v15
    v_fma_f32 v23, v23, s43, -v15
    v_fma_f32 v28, v28, s43, -v15
    v_fma_f32 v29, v29, s43, -v15
    v_fma_f32 v30, v30, s43, -v15
    v_fma_f32 v31, v31, s43, -v15
    v_exp_f32 v16, v16
    v_exp_f32 v17, v17
    v_exp_f32 v18, v18
    v_exp_f32 v19, v19
    v_exp_f32 v24, v24
    v_exp_f32 v25, v25
    v_exp_f32 v26, v26
    s_cbranch_vccnz L_w54
    s_waitcnt vmcnt(5)
L_w54:
    s_waitcnt vmcnt(6)
    buffer_load_dwordx4 v81, s[16:19], s42 offen offset:1024 nt lds
    v_add_u32 v81, 0x10000, v81
    v_exp_f32 v27, v27
    v_exp_f32 v20, v20
    v_exp_f32 v21, v21
    v_exp_f32 v22, v22
    v_exp_f32 v23, v23
    v_exp_f32 v28, v28
    v_exp_f32 v29, v29
    v_exp_f32 v30, v30
    v_exp_f32 v31, v31
    v_add_f32 v8, v16, v17
    v_add_f32 v10, v18, v19
    v_add_f32 v8, v8, v24
    s_cbranch_vccnz L_w55
    s_waitcnt vmcnt(5)
L_w55:
    s_waitcnt vmcnt(6)
    buffer_load_dwordx4 v82, s[16:19], s42 offen offset:2048 nt lds
    v_add_u32 v82, 0x10000, v82
    v_add_f32 v10, v10, v25
    v_add_f32 v8, v8, v26
    v_add_f32 v10, v10, v27
    v_add_f32 v8, v8, v10
    v_add_f32 v9, v20, v21
    v_add_f32 v11, v22, v23
    v_add_f32 v9, v9, v28
    v_add_f32 v11, v11, v29
    v_add_f32 v9, v9, v30
    v_add_f32 v11, v11, v31
    v_add_f32 v9, v9, v11
    v_cvt_pk_bf16_f32 v32, v16, v17
    v_cvt_pk_bf16_f32 v33, v18, v19
    v_cvt_pk_bf16_f32 v34, v24, v25
    v_cvt_pk_bf16_f32 v35, v26, v27
    v_cvt_pk_bf16_f32 v36, v20, v21
    v_cvt_pk_bf16_f32 v37, v22, v23
    v_cvt_pk_bf16_f32 v38, v28, v29
    v_cvt_pk_bf16_f32 v39, v30, v31
    v_permlane32_swap_b32 v8, v9
    v_add_f32 v8, v8, v9
    v_fma_f32 v6, v6, v7, v8
    s_cbranch_vccnz L_w56
    s_waitcnt vmcnt(5)
L_w56:
    s_waitcnt vmcnt(6)
    buffer_load_dwordx4 v83, s[16:19], s42 offen offset:3072 nt lds
    v_add_u32 v83, 0x10000, v83
    s_setpc_b64 s[68:69]
    .p2align 6
L_bodyV1:
    s_waitcnt vmcnt(8)
    ds_read_b64_tr_b16 v[40:41], v88 offset:8192
    ds_read_b64_tr_b16 v[42:43], v88 offset:12288
    ds_read_b64_tr_b16 v[44:45], v89 offset:8192
    ds_read_b64_tr_b16 v[46:47], v89 offset:12288
    ds_read_b64_tr_b16 v[48:49], v90 offset:8192
    ds_read_b64_tr_b16 v[50:51], v90 offset:12288
    ds_read_b64_tr_b16 v[52:53], v91 offset:8192
    ds_read_b64_tr_b16 v[54:55], v91 offset:12288
    ds_read_b64_tr_b16 v[56:57], v92 offset:8192
    ds_read_b64_tr_b16 v[58:59], v92 offset:12288
    ds_read_b64_tr_b16 v[60:61], v93 offset:8192
    ds_read_b64_tr_b16 v[62:63], v93 offset:12288
    ds_read_b64_tr_b16 v[64:65], v94 offset:8192
    ds_read_b64_tr_b16 v[66:67], v94 offset:12288
    ds_read_b64_tr_b16 v[68:69], v95 offset:8192
    ds_read_b64_tr_b16 v[70:71], v95 offset:12288
    v_cmp_lt_u32 vcc, v254, v253
    v_add_u32 v254, 2, v254
    s_mov_b64 exec, 1
    buffer_store_byte v254, v251, s[28:31], 0 offen
    s_mov_b64 exec, -1
    buffer_load_ubyte v253, v252, s[28:31], 0 offen nt
    s_bcnt1_i32_b32 s50, vcc_lo
    s_cmp_ge_u32 s50, 8
    s_cselect_b64 vcc, -1, 0
    v_permlane32_swap_b32 v12, v13
    v_mul_f32 v96, v96, v12
    v_mul_f32 v97, v97, v12
    v_mul_f32 v98, v98, v12
    v_mul_f32 v99, v99, v12
    v_mul_f32 v128, v128, v13
    v_mul_f32 v129, v129, v13
    v_mul_f32 v130, v130, v13
    v_mul_f32 v131, v131, v13
    s_waitcnt lgkmcnt(0)
    s_mov_b32 m0, s66
    s_cbranch_vccnz L_w57
    s_waitcnt vmcnt(7)
L_w57:
    s_waitcnt vmcnt(8)
    buffer_load_dwordx4 v80, s[16:19], 0 offen offset:0 nt lds
    v_mul_f32 v100, v100, v12
    v_mul_f32 v101, v101, v12
    v_mul_f32 v102, v102, v12
    v_mul_f32 v103, v103, v12
    v_mul_f32 v132, v132, v13
    v_mul_f32 v133, v133, v13
    v_mul_f32 v134, v134, v13
    v_mul_f32 v135, v135, v13
    v_mul_f32 v104, v104, v12
    v_mul_f32 v105, v105, v12
    v_mul_f32 v106, v106, v12
    v_mul_f32 v107, v107, v12
    v_mul_f32 v136, v136, v13
    v_mul_f32 v137, v137, v13
    v_mul_f32 v138, v138, v13
    s_cbranch_vccnz L_w58
    s_waitcnt vmcnt(6)
L_w58:
    s_waitcnt vmcnt(7)
    buffer_load_dwordx4 v81, s[16:19], 0 offen offset:1024 nt lds
    v_mul_f32 v139, v139, v13
    v_mfma_f32_16x16x32_bf16 v[96:99], v[40:43], v[32:35], v[96:99]
    v_mfma_f32_16x16x32_bf16 v[128:131], v[40:43], v[36:39], v[128:131]
    v_mul_f32 v108, v108, v12
    v_mul_f32 v109, v109, v12
    v_mul_f32 v110, v110, v12
    v_mul_f32 v111, v111, v12
    v_mul_f32 v140, v140, v13
    v_mul_f32 v141, v141, v13
    v_mul_f32 v142, v142, v13
    v_mul_f32 v143, v143, v13
    s_cbranch_vccnz L_w59
    s_waitcnt vmcnt(6)
L_w59:
    s_waitcnt vmcnt(7)
    buffer_load_dwordx4 v82, s[16:19], 0 offen offset:2048 nt lds
    v_mfma_f32_16x16x32_bf16 v[100:103], v[44:47], v[32:35], v[100:103]
    v_mfma_f32_16x16x32_bf16 v[132:135], v[44:47], v[36:39], v[132:135]
    v_mul_f32 v112, v112, v12
    v_mul_f32 v113, v113, v12
    v_mul_f32 v114, v114, v12
    v_mul_f32 v115, v115, v12
    v_mul_f32 v144, v144, v13
    v_mul_f32 v145, v145, v13
    v_mul_f32 v146, v146, v13
    v_mul_f32 v147, v147, v13
    v_mfma_f32_16x16x32_bf16 v[104:107], v[48:51], v[32:35], v[104:107]
    s_cbranch_vccnz L_w60
    s_waitcnt vmcnt(6)
L_w60:
    s_waitcnt vmcnt(7)
    buffer_load_dwordx4 v83, s[16:19], 0 offen offset:3072 nt lds
    v_mfma_f32_16x16x32_bf16 v[136:139], v[48:51], v[36:39], v[136:139]
    v_mul_f32 v116, v116, v12
    v_mul_f32 v117, v117, v12
    v_mul_f32 v118, v118, v12
    v_mul_f32 v119, v119, v12
    v_mul_f32 v148, v148, v13
    v_mul_f32 v149, v149, v13
    v_mul_f32 v150, v150, v13
    v_mul_f32 v151, v151, v13
    v_mfma_f32_16x16x32_bf16 v[108:111], v[52:55], v[32:35], v[108:111]
    v_add_u32 v3, 1, v254
    s_mov_b64 exec, 1
    buffer_store_byte v3, v251, s[28:31], 0 offen
    s_mov_b64 exec, -1
    s_mov_b32 m0, s67
    s_cbranch_vccnz L_w61
    s_waitcnt vmcnt(7)
L_w61:
    s_waitcnt vmcnt(8)
    buffer_load_dwordx4 v80, s[16:19], s42 offen offset:0 nt lds
    v_add_u32 v80, 0x10000, v80
    v_mfma_f32_16x16x32_bf16 v[140:143], v[52:55], v[36:39], v[140:143]
    v_mul_f32 v120, v120, v12
    v_mul_f32 v121, v121, v12
    v_mul_f32 v122, v122, v12
    v_mul_f32 v123, v123, v12
    v_mul_f32 v152, v152, v13
    v_mul_f32 v153, v153, v13
    v_mul_f32 v154, v154, v13
    v_mul_f32 v155, v155, v13
    v_mfma_f32_16x16x32_bf16 v[112:115], v[56:59], v[32:35], v[112:115]
    s_cbranch_vccnz L_w62
    s_waitcnt vmcnt(5)
L_w62:
    s_waitcnt vmcnt(6)
    buffer_load_dwordx4 v81, s[16:19], s42 offen offset:1024 nt lds
    v_add_u32 v81, 0x10000, v81
    v_mfma_f32_16x16x32_bf16 v[144:147], v[56:59], v[36:39], v[144:147]
    v_mul_f32 v124, v124, v12
    v_mul_f32 v125, v125, v12
    v_mul_f32 v126, v126, v12
    v_mul_f32 v127, v127, v12
    v_mul_f32 v156, v156, v13
    v_mul_f32 v157, v157, v13
    v_mul_f32 v158, v158, v13
    v_mul_f32 v159, v159, v13
    v_mfma_f32_16x16x32_bf16 v[116:119], v[60:63], v[32:35], v[116:119]
    v_mfma_f32_16x16x32_bf16 v[148:151], v[60:63], v[36:39], v[148:151]
    s_cbranch_vccnz L_w63
    s_waitcnt vmcnt(5)
L_w63:
    s_waitcnt vmcnt(6)
    buffer_load_dwordx4 v82, s[16:19], s42 offen offset:2048 nt lds
    v_add_u32 v82, 0x10000, v82
    v_mfma_f32_16x16x32_bf16 v[120:123], v[64:67], v[32:35], v[120:123]
    v_mfma_f32_16x16x32_bf16 v[152:155], v[64:67], v[36:39], v[152:155]
    v_mfma_f32_16x16x32_bf16 v[124:127], v[68:71], v[32:35], v[124:127]
    v_mfma_f32_16x16x32_bf16 v[156:159], v[68:71], v[36:39], v[156:159]
    s_cbranch_vccnz L_w64
    s_waitcnt vmcnt(5)
L_w64:
    s_waitcnt vmcnt(6)
    buffer_load_dwordx4 v83, s[16:19], s42 offen offset:3072 nt lds
    v_add_u32 v83, 0x10000, v83
    s_setpc_b64 s[68:69]
L_codeend:
.section .rodata,"a"
.p2align 6
.amdhsa_kernel standalone__gqa_softmax__sampling_kernel
  .amdhsa_next_free_vgpr 512
  .amdhsa_next_free_sgpr 80
  .amdhsa_accum_offset 256
  .amdhsa_group_segment_fixed_size 0
  .amdhsa_kernarg_size 48
  .amdhsa_user_sgpr_count 2
  .amdhsa_user_sgpr_kernarg_segment_ptr 1
  .amdhsa_system_sgpr_workgroup_id_x 1
.end_amdhsa_kernel
```
